```python
import torch

def _softmax(x, axis=-1):
    return torch.softmax(x, dim=axis)
def _gelu(x):
    return torch.nn.functional.gelu(x, approximate="tanh")
def _silu(x):
    return torch.nn.functional.silu(x)
def _sigmoid(x):
    return torch.sigmoid(x)
def _layernorm(x, axis=-1, eps=1e-5):
    m = x.mean(dim=axis, keepdim=True)
    v = x.var(dim=axis, keepdim=True, unbiased=False)
    return (x - m) / torch.sqrt(v + eps)
def _scatter_add(tgt, idx, src, axis=0):
    return tgt.clone().index_add_(axis, idx, src)
def _segment_sum(src, seg, n):
    out = torch.zeros((n,) + src.shape[1:], dtype=src.dtype)
    return out.index_add_(0, seg, src)
def _pad(x, pw):
    flat = tuple(v for pair in reversed(pw) for v in pair)
    return torch.nn.functional.pad(x, flat)

kernel_name = 'parallel_sum__sliding_block__mixer_token_mlp__prompt'

def setup_inputs():

    _w = (lambda a: (lambda t: t.to(torch.bfloat16) if t.is_floating_point() else t)(torch.as_tensor(a)))
    def _A_setup():
        B, S, D = 1, 2048, 512
        return {
            "x": _w((lambda *s: torch.randn(*s, dtype=torch.bfloat16) * 0.05)(B, S, D)),
            "wqkv": _w((lambda *s: torch.randn(*s, dtype=torch.bfloat16) * 0.05)(D, 3 * D)),
            "wo": _w((lambda *s: torch.randn(*s, dtype=torch.bfloat16) * 0.05)(D, D)),
        }
    _A_in = _A_setup()

    def _B_setup():
        B, S, D, F = 1, 2048, 512, 1376
        return {
            "x": _w((lambda *s: torch.randn(*s, dtype=torch.bfloat16) * 0.05)(B, S, D)),
            "w1": _w((lambda *s: torch.randn(*s, dtype=torch.bfloat16) * 1.6)(S, F) * (S ** -0.5)),
            "b1": _w((lambda *s: torch.randn(*s, dtype=torch.bfloat16) * 12.8)(F) * 0.02),
            "w2": _w((lambda *s: torch.randn(*s, dtype=torch.bfloat16) * 0.4)(F, S) * (F ** -0.5)),
            "b2": _w((lambda *s: torch.randn(*s, dtype=torch.bfloat16) * 6.4)(S) * 0.02),
        }
    _B_in = _B_setup()

    return {
        "A_x": _A_in["x"],
        "A_wqkv": _A_in["wqkv"],
        "A_wo": _A_in["wo"],
        "B_x": _B_in["x"],
        "B_w1": _B_in["w1"],
        "B_b1": _B_in["b1"],
        "B_w2": _B_in["w2"],
        "B_b2": _B_in["b2"],
    }

def reference(A_x, A_wqkv, A_wo, B_x, B_w1, B_b1, B_w2, B_b2):
    def _A_ref(x, wqkv, wo):
        B, S, D = x.shape
        H = 32; Dh = D // H; W = 256
        qkv = (lambda x, *d: x.permute(*d))((x @ wqkv).reshape(B, S, 3, H, Dh), 2, 0, 3, 1, 4)
        q, k, v = qkv[0], qkv[1], qkv[2]
        scores = torch.einsum("bhqd,bhkd->bhqk", q, k) * (Dh ** -0.5)
        idx = torch.arange(S)
        mask = (idx[:, None] - idx[None, :] >= 0) & (idx[:, None] - idx[None, :] < W)
        scores = torch.where(mask[None, None], scores, -1e9)
        p = _softmax(scores, axis=-1)
        o = torch.einsum("bhqk,bhkd->bhqd", p, v)
        return (lambda x, *d: x.permute(*d))(o, 0, 2, 1, 3).reshape(B, S, D) @ wo

    def _B_ref(x, w1, b1, w2, b2):
        B, S, D = x.shape
        h = _layernorm(x, axis=-1)
        u = torch.einsum("bsd,sf->bdf", h, w1) + b1
        u = _gelu(u)
        y = torch.einsum("bdf,fs->bds", u, w2) + b2
        return (lambda x, *d: x.permute(*d))(y, 0, 2, 1)

    x = A_x
    xn = _layernorm(x, axis=-1)
    return x + _A_ref(xn, A_wqkv, A_wo) + _B_ref(xn, B_w1, B_b1, B_w2, B_b2)
```

```asm
; @launch grid=(256,1,1) block=(512,1,1) lds=163840
.amdgcn_target "amdgcn-amd-amdhsa--gfx950"
.text
.globl parallel_sum__sliding_block__mixer_token_mlp__prompt_kernel
.p2align 8
.type parallel_sum__sliding_block__mixer_token_mlp__prompt_kernel,@function
parallel_sum__sliding_block__mixer_token_mlp__prompt_kernel:
  s_cmp_ge_u32 s2, 256
  s_cbranch_scc1 L_end
  s_load_dwordx16 s[64:79], s[0:1], 0
  s_load_dwordx4 s[80:83], s[0:1], 64
  s_load_dwordx2 s[84:85], s[0:1], 80
  s_getpc_b64 s[86:87]
L_pc:
  s_lshr_b32 s88, s2, 3
  v_lshl_add_u32 v251, v0, 5, s88
  v_lshlrev_b32 v251, 7, v251
  s_mov_b32 s88, 16
  v_min_u32 v251, CODE_END-L_pc-4, v251
  v_cmp_gt_u32 vcc, s88, v0
  s_nop 3
  s_and_saveexec_b64 s[88:89], vcc
  s_cbranch_execz L_nocp
  global_load_dword v251, v251, s[86:87]
L_nocp:
  s_mov_b64 exec, -1
  s_xor_b32 s2, s2, 8
  v_lshrrev_b32 v2, 6, v0
  v_and_b32 v1, 63, v0
  v_readfirstlane_b32 s3, v2
  s_and_b32 s28, s2, 7
  s_lshr_b32 s86, s2, 3
  s_lshr_b32 s25, s28, 1
  s_and_b32 s26, s28, 1
  s_lshr_b32 s27, s86, 1
  s_lshr_b32 s87, s86, 2
  s_lshl_b32 s29, s25, 3
  s_add_u32 s29, s29, s87
  s_and_b32 s88, s86, 3
  s_lshl_b32 s30, s26, 2
  s_add_u32 s30, s30, s88
  s_and_b32 s24, s3, 3
  s_lshl_b32 s97, s88, 1
  s_add_u32 s97, s97, s87
  s_mul_i32 s97, s97, 11
  s_lshr_b32 s97, s97, 3
  s_mul_i32 s99, s26, 3
  s_add_u32 s97, s97, s99
  s_cmp_ge_u32 s97, 11
  s_cselect_b32 s99, 11, 0
  s_sub_u32 s97, s97, s99
  s_add_u32 s99, s88, s87
  s_and_b32 s99, s99, 3
  s_bitcmp1_b32 s2, 3
  s_cbranch_scc1 B_entry
  s_lshr_b32 s28, s27, 2
  s_lshl_b32 s95, s25, 2
  s_add_u32 s95, s95, s28
  s_and_b32 s28, s27, 3
  s_lshl_b32 s94, s26, 2
  s_add_u32 s94, s94, s28
  s_cmp_ge_u32 s3, 4
  s_cbranch_scc1 A_load
  s_branch A_cons
A_load:
  v_lshrrev_b32 v10, 3, v1
  s_lshl_b32 s28, s24, 4
  v_add_u32 v10, s28, v10
  v_lshrrev_b32 v11, 4, v1
  v_and_b32 v12, 7, v1
  v_xor_b32 v13, v11, v12
  v_lshlrev_b32 v14, 10, v10
  s_lshl_b32 s28, s95, 17
  v_add_u32 v14, s28, v14
  v_lshl_add_u32 v2, v13, 4, v14
  v_xor_b32 v3, 64, v2
  v_add_u32 v3, 7168, v3
  v_and_b32 v11, 1, v11
  v_lshlrev_b32 v11, 2, v11
  v_xor_b32 v13, v11, v12
  v_mul_u32_u24 v14, 3072, v10
  s_lshl_b32 s28, s94, 7
  v_add_u32 v14, s28, v14
  v_lshl_add_u32 v4, v13, 4, v14
  v_add_u32 v5, 23552, v4
  s_lshl_b32 s89, s24, 11
  s_waitcnt lgkmcnt(0)
  s_mov_b32 s4, s64
  s_mov_b32 s5, s65
  s_mov_b32 s6, 2097152
  s_mov_b32 s7, 0x00020000
  s_mov_b32 s8, s66
  s_mov_b32 s9, s67
  s_mov_b32 s10, 1572864
  s_mov_b32 s11, 0x00020000
  s_add_u32 s98, s95, s94
  s_and_b32 s98, s98, 3
  s_lshl_b32 s98, s98, 1
  s_lshl_b32 s87, s98, 7
  s_mul_i32 s88, s98, 196608
  s_add_u32 s98, s98, 1
  s_and_b32 s98, s98, 7
  s_add_u32 m0, s89, 0
  s_add_u32 s90, s87, 0
  buffer_load_dwordx4 v2, s[4:7], s90 offen lds
  buffer_load_dwordx4 v3, s[4:7], s90 offen offset:1024 lds
  s_add_u32 m0, s89, 8192
  s_add_u32 s90, s87, 65536
  buffer_load_dwordx4 v2, s[4:7], s90 offen lds
  buffer_load_dwordx4 v3, s[4:7], s90 offen offset:1024 lds
  s_add_u32 m0, s89, 16384
  s_add_u32 s90, s88, 0
  buffer_load_dwordx4 v4, s[8:11], s90 offen lds
  buffer_load_dwordx4 v5, s[8:11], s90 offen offset:1024 lds
  s_add_u32 m0, s89, 24576
  s_add_u32 s90, s88, 1024
  buffer_load_dwordx4 v4, s[8:11], s90 offen lds
  buffer_load_dwordx4 v5, s[8:11], s90 offen offset:1024 lds
  s_add_u32 m0, s89, 32768
  s_add_u32 s90, s88, 2048
  buffer_load_dwordx4 v4, s[8:11], s90 offen lds
  buffer_load_dwordx4 v5, s[8:11], s90 offen offset:1024 lds
  s_mov_b32 s28, 10485760
  s_load_dword s31, s[84:85], s28
  s_mov_b32 s12, s84
  s_mov_b32 s13, s85
  s_mov_b32 s14, 10850304
  s_mov_b32 s15, 0x00020000
  s_mov_b32 s16, s76
  s_mov_b32 s17, s77
  s_mov_b32 s18, 5636096
  s_mov_b32 s19, 0x00020000
  s_mov_b32 s20, s68
  s_mov_b32 s21, s69
  s_mov_b32 s22, 524288
  s_mov_b32 s23, 0x00020000
  v_lshrrev_b32 v248, 3, v1
  s_lshl_b32 s28, s24, 5
  v_add_u32 v248, s28, v248
  v_bfe_u32 v249, v1, 4, 1
  v_lshlrev_b32 v249, 2, v249
  v_and_b32 v250, 7, v1
  v_xor_b32 v249, v249, v250
  v_lshlrev_b32 v249, 4, v249
  s_lshl_b32 s28, s29, 7
  v_mul_u32_u24 v240, 4096, v248
  v_add3_u32 v240, v240, v249, s28
  v_add_u32 v241, 31744, v240
  v_add_u32 v242, 63488, v240
  v_add_u32 v243, 95232, v240
  s_lshl_b32 s28, s30, 7
  v_mul_u32_u24 v244, 1024, v248
  v_add3_u32 v244, v244, v249, s28
  v_add_u32 v245, 7168, v244
  v_add_u32 v246, 14336, v244
  v_add_u32 v247, 21504, v244
  v_mov_b32 v252, 10485888
  v_mov_b32 v6, 126976
  v_mov_b32 v7, 0
  ds_write_b32 v6, v7
  s_waitcnt lgkmcnt(0)
  s_add_u32 s31, s31, 1
  s_mov_b32 s32, s72
  s_mov_b32 s33, s73
  s_mov_b32 s34, 5636096
  s_mov_b32 s35, 0x00020000
  s_lshl_b32 s28, s27, 2
  s_add_u32 s28, s28, s24
  s_lshl_b32 s28, s28, 4
  s_add_u32 s28, s28, 1024
  s_lshl_b32 s86, s26, 20
  s_add_u32 s28, s28, s86
  s_and_b32 s28, s28, 2047
  v_lshrrev_b32 v16, 3, v1
  v_add_u32 v16, s28, v16
  v_mul_u32_u24 v16, 2752, v16
  v_and_b32 v17, 7, v1
  v_min_u32 v17, 6, v17
  v_lshl_add_u32 v16, v17, 7, v16
  s_mul_i32 s36, s25, 768
  s_add_u32 s37, s36, 22016
  s_lshl_b32 s28, s27, 2
  s_add_u32 s28, s28, s24
  s_and_b32 s38, s28, 7
  s_lshl_b32 s38, s38, 17
  s_lshr_b32 s28, s28, 3
  s_lshl_b32 s28, s28, 13
  s_add_u32 s38, s38, s28
  s_lshl_b32 s28, s26, 20
  s_add_u32 s38, s38, s28
  s_add_u32 s38, s38, 65536
  s_lshl_b32 s28, s26, 16
  s_nop 0
  v_lshlrev_b32 v19, 7, v1
  s_lshl_b32 s87, s98, 7
  s_mul_i32 s88, s98, 196608
  s_add_u32 s98, s98, 1
  s_and_b32 s98, s98, 7
  s_add_u32 m0, s89, 40960
  s_add_u32 s90, s87, 0
  buffer_load_dwordx4 v2, s[4:7], s90 offen lds
  buffer_load_dwordx4 v3, s[4:7], s90 offen offset:1024 lds
  s_add_u32 m0, s89, 49152
  s_add_u32 s90, s87, 65536
  buffer_load_dwordx4 v2, s[4:7], s90 offen lds
  buffer_load_dwordx4 v3, s[4:7], s90 offen offset:1024 lds
  s_add_u32 m0, s89, 57344
  s_add_u32 s90, s88, 0
  buffer_load_dwordx4 v4, s[8:11], s90 offen lds
  buffer_load_dwordx4 v5, s[8:11], s90 offen offset:1024 lds
  s_add_u32 m0, s89, 65536
  s_add_u32 s90, s88, 1024
  buffer_load_dwordx4 v4, s[8:11], s90 offen lds
  buffer_load_dwordx4 v5, s[8:11], s90 offen offset:1024 lds
  s_add_u32 m0, s89, 73728
  s_add_u32 s90, s88, 2048
  buffer_load_dwordx4 v4, s[8:11], s90 offen lds
  buffer_load_dwordx4 v5, s[8:11], s90 offen offset:1024 lds
  s_waitcnt vmcnt(10)
  s_barrier
  s_lshl_b32 s87, s98, 7
  s_mul_i32 s88, s98, 196608
  s_add_u32 s98, s98, 1
  s_and_b32 s98, s98, 7
  s_add_u32 m0, s89, 81920
  s_add_u32 s90, s87, 0
  buffer_load_dwordx4 v2, s[4:7], s90 offen lds
  buffer_load_dwordx4 v3, s[4:7], s90 offen offset:1024 lds
  s_add_u32 m0, s89, 90112
  s_add_u32 s90, s87, 65536
  buffer_load_dwordx4 v2, s[4:7], s90 offen lds
  buffer_load_dwordx4 v3, s[4:7], s90 offen offset:1024 lds
  s_add_u32 m0, s89, 98304
  s_add_u32 s90, s88, 0
  buffer_load_dwordx4 v4, s[8:11], s90 offen lds
  buffer_load_dwordx4 v5, s[8:11], s90 offen offset:1024 lds
  s_add_u32 m0, s89, 106496
  s_add_u32 s90, s88, 1024
  buffer_load_dwordx4 v4, s[8:11], s90 offen lds
  buffer_load_dwordx4 v5, s[8:11], s90 offen offset:1024 lds
  s_add_u32 m0, s89, 114688
  s_add_u32 s90, s88, 2048
  buffer_load_dwordx4 v4, s[8:11], s90 offen lds
  buffer_load_dwordx4 v5, s[8:11], s90 offen offset:1024 lds
  s_waitcnt vmcnt(10)
  s_barrier
  s_lshl_b32 s87, s98, 7
  s_mul_i32 s88, s98, 196608
  s_add_u32 s98, s98, 1
  s_and_b32 s98, s98, 7
  s_add_u32 m0, s89, 0
  s_add_u32 s90, s87, 0
  buffer_load_dwordx4 v2, s[4:7], s90 offen lds
  buffer_load_dwordx4 v3, s[4:7], s90 offen offset:1024 lds
  s_add_u32 m0, s89, 8192
  s_add_u32 s90, s87, 65536
  buffer_load_dwordx4 v2, s[4:7], s90 offen lds
  buffer_load_dwordx4 v3, s[4:7], s90 offen offset:1024 lds
  s_add_u32 m0, s89, 16384
  s_add_u32 s90, s88, 0
  buffer_load_dwordx4 v4, s[8:11], s90 offen lds
  buffer_load_dwordx4 v5, s[8:11], s90 offen offset:1024 lds
  s_add_u32 m0, s89, 24576
  s_add_u32 s90, s88, 1024
  buffer_load_dwordx4 v4, s[8:11], s90 offen lds
  buffer_load_dwordx4 v5, s[8:11], s90 offen offset:1024 lds
  s_add_u32 m0, s89, 32768
  s_add_u32 s90, s88, 2048
  buffer_load_dwordx4 v4, s[8:11], s90 offen lds
  buffer_load_dwordx4 v5, s[8:11], s90 offen offset:1024 lds
  s_waitcnt vmcnt(10)
  s_barrier
  s_lshl_b32 s87, s98, 7
  s_mul_i32 s88, s98, 196608
  s_add_u32 s98, s98, 1
  s_and_b32 s98, s98, 7
  s_add_u32 m0, s89, 40960
  s_add_u32 s90, s87, 0
  buffer_load_dwordx4 v2, s[4:7], s90 offen lds
  buffer_load_dwordx4 v3, s[4:7], s90 offen offset:1024 lds
  s_add_u32 m0, s89, 49152
  s_add_u32 s90, s87, 65536
  buffer_load_dwordx4 v2, s[4:7], s90 offen lds
  buffer_load_dwordx4 v3, s[4:7], s90 offen offset:1024 lds
  s_add_u32 m0, s89, 57344
  s_add_u32 s90, s88, 0
  buffer_load_dwordx4 v4, s[8:11], s90 offen lds
  buffer_load_dwordx4 v5, s[8:11], s90 offen offset:1024 lds
  s_add_u32 m0, s89, 65536
  s_add_u32 s90, s88, 1024
  buffer_load_dwordx4 v4, s[8:11], s90 offen lds
  buffer_load_dwordx4 v5, s[8:11], s90 offen offset:1024 lds
  s_add_u32 m0, s89, 73728
  s_add_u32 s90, s88, 2048
  buffer_load_dwordx4 v4, s[8:11], s90 offen lds
  buffer_load_dwordx4 v5, s[8:11], s90 offen offset:1024 lds
  s_waitcnt vmcnt(10)
  s_barrier
  s_lshl_b32 s87, s98, 7
  s_mul_i32 s88, s98, 196608
  s_add_u32 s98, s98, 1
  s_and_b32 s98, s98, 7
  s_add_u32 m0, s89, 81920
  s_add_u32 s90, s87, 0
  buffer_load_dwordx4 v2, s[4:7], s90 offen lds
  buffer_load_dwordx4 v3, s[4:7], s90 offen offset:1024 lds
  s_add_u32 m0, s89, 90112
  s_add_u32 s90, s87, 65536
  buffer_load_dwordx4 v2, s[4:7], s90 offen lds
  buffer_load_dwordx4 v3, s[4:7], s90 offen offset:1024 lds
  s_add_u32 m0, s89, 98304
  s_add_u32 s90, s88, 0
  buffer_load_dwordx4 v4, s[8:11], s90 offen lds
  buffer_load_dwordx4 v5, s[8:11], s90 offen offset:1024 lds
  s_add_u32 m0, s89, 106496
  s_add_u32 s90, s88, 1024
  buffer_load_dwordx4 v4, s[8:11], s90 offen lds
  buffer_load_dwordx4 v5, s[8:11], s90 offen offset:1024 lds
  s_add_u32 m0, s89, 114688
  s_add_u32 s90, s88, 2048
  buffer_load_dwordx4 v4, s[8:11], s90 offen lds
  buffer_load_dwordx4 v5, s[8:11], s90 offen offset:1024 lds
  s_waitcnt vmcnt(10)
  s_barrier
  s_lshl_b32 s87, s98, 7
  s_mul_i32 s88, s98, 196608
  s_add_u32 s98, s98, 1
  s_and_b32 s98, s98, 7
  s_add_u32 m0, s89, 0
  s_add_u32 s90, s87, 0
  buffer_load_dwordx4 v2, s[4:7], s90 offen nt lds
  buffer_load_dwordx4 v3, s[4:7], s90 offen offset:1024 nt lds
  s_add_u32 m0, s89, 8192
  s_add_u32 s90, s87, 65536
  buffer_load_dwordx4 v2, s[4:7], s90 offen nt lds
  buffer_load_dwordx4 v3, s[4:7], s90 offen offset:1024 nt lds
  s_add_u32 m0, s89, 16384
  s_add_u32 s90, s88, 0
  buffer_load_dwordx4 v4, s[8:11], s90 offen nt lds
  buffer_load_dwordx4 v5, s[8:11], s90 offen offset:1024 nt lds
  s_add_u32 m0, s89, 24576
  s_add_u32 s90, s88, 1024
  buffer_load_dwordx4 v4, s[8:11], s90 offen nt lds
  buffer_load_dwordx4 v5, s[8:11], s90 offen offset:1024 nt lds
  s_add_u32 m0, s89, 32768
  s_add_u32 s90, s88, 2048
  buffer_load_dwordx4 v4, s[8:11], s90 offen nt lds
  buffer_load_dwordx4 v5, s[8:11], s90 offen offset:1024 nt lds
  s_waitcnt vmcnt(10)
  s_barrier
  s_lshl_b32 s87, s98, 7
  s_mul_i32 s88, s98, 196608
  s_add_u32 s98, s98, 1
  s_and_b32 s98, s98, 7
  s_add_u32 m0, s89, 40960
  s_add_u32 s90, s87, 0
  buffer_load_dwordx4 v2, s[4:7], s90 offen nt lds
  buffer_load_dwordx4 v3, s[4:7], s90 offen offset:1024 nt lds
  s_add_u32 m0, s89, 49152
  s_add_u32 s90, s87, 65536
  buffer_load_dwordx4 v2, s[4:7], s90 offen nt lds
  buffer_load_dwordx4 v3, s[4:7], s90 offen offset:1024 nt lds
  s_add_u32 m0, s89, 57344
  s_add_u32 s90, s88, 0
  buffer_load_dwordx4 v4, s[8:11], s90 offen nt lds
  buffer_load_dwordx4 v5, s[8:11], s90 offen offset:1024 nt lds
  s_add_u32 m0, s89, 65536
  s_add_u32 s90, s88, 1024
  buffer_load_dwordx4 v4, s[8:11], s90 offen nt lds
  buffer_load_dwordx4 v5, s[8:11], s90 offen offset:1024 nt lds
  s_add_u32 m0, s89, 73728
  s_add_u32 s90, s88, 2048
  buffer_load_dwordx4 v4, s[8:11], s90 offen nt lds
  buffer_load_dwordx4 v5, s[8:11], s90 offen offset:1024 nt lds
  buffer_load_dword v251, v16, s[32:35], s36 offen
  s_waitcnt vmcnt(11)
  s_barrier
  buffer_load_dword v251, v16, s[32:35], s37 offen
  buffer_load_dword v251, v19, s[12:15], s38 offen sc1
  s_waitcnt vmcnt(3)
  s_barrier
  s_barrier
  s_branch A_attn
A_cons:
  v_mov_b32 v240, 0
  v_mov_b32 v241, 0
  v_mov_b32 v242, 0
  v_mov_b32 v243, 0
  v_mov_b32 v244, 0
  v_mov_b32 v245, 0
  v_mov_b32 v246, 0
  v_mov_b32 v247, 0
  s_and_b32 s91, s24, 1
  s_lshr_b32 s92, s24, 1
  v_lshrrev_b32 v23, 5, v1
  v_and_b32 v24, 31, v1
  v_bfe_u32 v26, v1, 1, 3
  v_xor_b32 v26, v26, v23
  s_lshl_b32 s28, s91, 13
  v_lshlrev_b32 v27, 7, v24
  v_add_u32 v27, s28, v27
  s_xor_b32 s28, s91, 0
  s_lshl_b32 s28, s28, 1
  v_xor_b32 v28, s28, v26
  v_lshl_add_u32 v2, v28, 4, v27
  v_add_u32 v6, 0x10000, v2
  s_xor_b32 s28, s91, 1
  s_lshl_b32 s28, s28, 1
  v_xor_b32 v28, s28, v26
  v_lshl_add_u32 v3, v28, 4, v27
  v_add_u32 v7, 0x10000, v3
  s_xor_b32 s28, s91, 2
  s_lshl_b32 s28, s28, 1
  v_xor_b32 v28, s28, v26
  v_lshl_add_u32 v4, v28, 4, v27
  v_add_u32 v8, 0x10000, v4
  s_xor_b32 s28, s91, 3
  s_lshl_b32 s28, s28, 1
  v_xor_b32 v28, s28, v26
  v_lshl_add_u32 v5, v28, 4, v27
  v_add_u32 v9, 0x10000, v5
  v_bfe_u32 v26, v1, 2, 2
  v_lshl_add_u32 v27, v23, 3, v26
  v_lshlrev_b32 v27, 7, v27
  v_bfe_u32 v28, v1, 4, 1
  v_lshlrev_b32 v28, 1, v28
  v_bfe_u32 v29, v1, 1, 1
  v_add_u32 v28, v28, v29
  s_lshl_b32 s28, s92, 2
  v_add_u32 v28, s28, v28
  v_bfe_u32 v29, v1, 3, 1
  v_lshlrev_b32 v29, 2, v29
  v_xor_b32 v28, v28, v29
  v_lshl_add_u32 v27, v28, 4, v27
  v_and_b32 v29, 1, v1
  v_lshl_add_u32 v27, v29, 3, v27
  s_lshl_b32 s28, s91, 11
  v_add_u32 v10, s28, v27
  v_xor_b32 v11, 2048, v10
  v_add_u32 v12, 0x10000, v10
  v_add_u32 v13, 0x10000, v11
  v_and_b32 v26, 15, v1
  v_bfe_u32 v27, v1, 4, 1
  v_cmp_eq_u32 vcc, v26, v27
  v_mov_b32 v28, 0x3f803f80
  s_nop 0
  v_cndmask_b32 v28, 0, v28, vcc
  v_mov_b32 v29, v28
  v_mov_b32 v30, v28
  v_mov_b32 v31, v28
  s_mul_i32 s28, s24, 384
  s_add_u32 s28, s28, 122880
  v_lshl_add_u32 v14, v1, 2, s28
  s_mul_i32 s28, s92, 768
  s_add_u32 s28, s28, 122880
  v_lshl_add_u32 v15, v23, 4, s28
  v_lshl_add_u32 v16, v24, 2, s28
  s_lshl_b32 s28, s24, 9
  s_add_u32 s28, s28, 124416
  v_lshl_add_u32 v17, v1, 2, s28
  v_lshl_add_u32 v18, v23, 4, s28
  v_lshl_add_u32 v25, v24, 2, s28
  s_lshl_b32 s28, s95, 7
  s_lshl_b32 s86, s91, 6
  s_add_u32 s28, s28, s86
  s_lshl_b32 s28, s28, 4
  s_add_u32 s28, s28, 10489856
  v_lshl_add_u32 v19, v1, 4, s28
  s_waitcnt lgkmcnt(0)
  s_mov_b32 s28, 10485760
  s_load_dword s31, s[84:85], s28
  s_mov_b32 s12, s84
  s_mov_b32 s13, s85
  s_mov_b32 s14, 10850304
  s_mov_b32 s15, 0x00020000
  s_waitcnt lgkmcnt(0)
  s_add_u32 s31, s31, 1
  s_barrier
  ds_read_b128 v[140:143], v2 offset:0
  ds_read_b128 v[144:147], v2 offset:4096
  ds_read_b64_tr_b16 v[148:149], v10 offset:16384
  ds_read_b64_tr_b16 v[150:151], v10 offset:16896
  ds_read_b64_tr_b16 v[152:153], v10 offset:24576
  ds_read_b64_tr_b16 v[154:155], v10 offset:25088
  ds_read_b64_tr_b16 v[156:157], v10 offset:32768
  ds_read_b64_tr_b16 v[158:159], v10 offset:33280
  ds_read_b128 v[160:163], v3 offset:0
  ds_read_b128 v[164:167], v3 offset:4096
  ds_read_b64_tr_b16 v[168:169], v11 offset:16384
  ds_read_b64_tr_b16 v[170:171], v11 offset:16896
  ds_read_b64_tr_b16 v[172:173], v11 offset:24576
  ds_read_b64_tr_b16 v[174:175], v11 offset:25088
  ds_read_b64_tr_b16 v[176:177], v11 offset:32768
  ds_read_b64_tr_b16 v[178:179], v11 offset:33280
  s_waitcnt lgkmcnt(8)
  v_mfma_f32_32x32x16_bf16 v[32:47], v[148:151], v[140:143], 0
  ds_read_b128 v[180:183], v4 offset:0
  ds_read_b128 v[184:187], v4 offset:4096
  v_mfma_f32_32x32x16_bf16 v[48:63], v[148:151], v[144:147], 0
  ds_read_b64_tr_b16 v[188:189], v10 offset:20480
  ds_read_b64_tr_b16 v[190:191], v10 offset:20992
  v_mfma_f32_32x32x16_bf16 v[64:79], v[152:155], v[140:143], 0
  ds_read_b64_tr_b16 v[192:193], v10 offset:28672
  v_mfma_f32_32x32x16_bf16 v[80:95], v[152:155], v[144:147], 0
  ds_read_b64_tr_b16 v[194:195], v10 offset:29184
  ds_read_b64_tr_b16 v[196:197], v10 offset:36864
  v_mfma_f32_32x32x16_bf16 v[96:111], v[140:143], v[156:159], 0
  ds_read_b64_tr_b16 v[198:199], v10 offset:37376
  v_mfma_f32_32x32x16_bf16 v[112:127], v[144:147], v[156:159], 0
  v_mfma_f32_16x16x32_bf16 v[128:131], v[28:31], v[148:151], 0
  v_mfma_f32_16x16x32_bf16 v[132:135], v[28:31], v[152:155], 0
  v_mfma_f32_16x16x32_bf16 v[136:139], v[28:31], v[156:159], 0
  s_waitcnt lgkmcnt(8)
  v_mfma_f32_32x32x16_bf16 v[32:47], v[168:171], v[160:163], v[32:47]
  ds_read_b128 v[140:143], v5 offset:0
  ds_read_b128 v[144:147], v5 offset:4096
  v_mfma_f32_32x32x16_bf16 v[48:63], v[168:171], v[164:167], v[48:63]
  ds_read_b64_tr_b16 v[148:149], v11 offset:20480
  ds_read_b64_tr_b16 v[150:151], v11 offset:20992
  v_mfma_f32_32x32x16_bf16 v[64:79], v[172:175], v[160:163], v[64:79]
  ds_read_b64_tr_b16 v[152:153], v11 offset:28672
  v_mfma_f32_32x32x16_bf16 v[80:95], v[172:175], v[164:167], v[80:95]
  ds_read_b64_tr_b16 v[154:155], v11 offset:29184
  ds_read_b64_tr_b16 v[156:157], v11 offset:36864
  v_mfma_f32_32x32x16_bf16 v[96:111], v[160:163], v[176:179], v[96:111]
  ds_read_b64_tr_b16 v[158:159], v11 offset:37376
  v_mfma_f32_32x32x16_bf16 v[112:127], v[164:167], v[176:179], v[112:127]
  s_waitcnt lgkmcnt(8)
  v_mfma_f32_32x32x16_bf16 v[32:47], v[188:191], v[180:183], v[32:47]
  v_mfma_f32_32x32x16_bf16 v[48:63], v[188:191], v[184:187], v[48:63]
  s_waitcnt lgkmcnt(0)
  s_barrier
  v_mfma_f32_32x32x16_bf16 v[64:79], v[192:195], v[180:183], v[64:79]
  ds_read_b128 v[160:163], v2 offset:40960
  ds_read_b128 v[164:167], v2 offset:45056
  v_mfma_f32_32x32x16_bf16 v[80:95], v[192:195], v[184:187], v[80:95]
  ds_read_b64_tr_b16 v[168:169], v10 offset:57344
  ds_read_b64_tr_b16 v[170:171], v10 offset:57856
  v_mfma_f32_32x32x16_bf16 v[96:111], v[180:183], v[196:199], v[96:111]
  ds_read_b64_tr_b16 v[172:173], v12 offset:0
  ds_read_b64_tr_b16 v[174:175], v12 offset:512
  v_mfma_f32_32x32x16_bf16 v[112:127], v[184:187], v[196:199], v[112:127]
  ds_read_b64_tr_b16 v[176:177], v12 offset:8192
  ds_read_b64_tr_b16 v[178:179], v12 offset:8704
  v_mfma_f32_16x16x32_bf16 v[128:131], v[28:31], v[188:191], v[128:131]
  v_mfma_f32_16x16x32_bf16 v[132:135], v[28:31], v[192:195], v[132:135]
  v_mfma_f32_16x16x32_bf16 v[136:139], v[28:31], v[196:199], v[136:139]
  s_waitcnt lgkmcnt(8)
  v_mfma_f32_32x32x16_bf16 v[32:47], v[148:151], v[140:143], v[32:47]
  ds_read_b128 v[180:183], v3 offset:40960
  ds_read_b128 v[184:187], v3 offset:45056
  v_mfma_f32_32x32x16_bf16 v[48:63], v[148:151], v[144:147], v[48:63]
  ds_read_b64_tr_b16 v[188:189], v11 offset:57344
  ds_read_b64_tr_b16 v[190:191], v11 offset:57856
  v_mfma_f32_32x32x16_bf16 v[64:79], v[152:155], v[140:143], v[64:79]
  ds_read_b64_tr_b16 v[192:193], v13 offset:0
  v_mfma_f32_32x32x16_bf16 v[80:95], v[152:155], v[144:147], v[80:95]
  ds_read_b64_tr_b16 v[194:195], v13 offset:512
  ds_read_b64_tr_b16 v[196:197], v13 offset:8192
  v_mfma_f32_32x32x16_bf16 v[96:111], v[140:143], v[156:159], v[96:111]
  ds_read_b64_tr_b16 v[198:199], v13 offset:8704
  v_mfma_f32_32x32x16_bf16 v[112:127], v[144:147], v[156:159], v[112:127]
  s_waitcnt lgkmcnt(8)
  v_mfma_f32_32x32x16_bf16 v[32:47], v[168:171], v[160:163], v[32:47]
  ds_read_b128 v[140:143], v4 offset:40960
  ds_read_b128 v[144:147], v4 offset:45056
  v_mfma_f32_32x32x16_bf16 v[48:63], v[168:171], v[164:167], v[48:63]
  ds_read_b64_tr_b16 v[148:149], v10 offset:61440
  ds_read_b64_tr_b16 v[150:151], v10 offset:61952
  v_mfma_f32_32x32x16_bf16 v[64:79], v[172:175], v[160:163], v[64:79]
  ds_read_b64_tr_b16 v[152:153], v12 offset:4096
  v_mfma_f32_32x32x16_bf16 v[80:95], v[172:175], v[164:167], v[80:95]
  ds_read_b64_tr_b16 v[154:155], v12 offset:4608
  ds_read_b64_tr_b16 v[156:157], v12 offset:12288
  v_mfma_f32_32x32x16_bf16 v[96:111], v[160:163], v[176:179], v[96:111]
  ds_read_b64_tr_b16 v[158:159], v12 offset:12800
  v_mfma_f32_32x32x16_bf16 v[112:127], v[164:167], v[176:179], v[112:127]
  v_mfma_f32_16x16x32_bf16 v[128:131], v[28:31], v[168:171], v[128:131]
  v_mfma_f32_16x16x32_bf16 v[132:135], v[28:31], v[172:175], v[132:135]
  v_mfma_f32_16x16x32_bf16 v[136:139], v[28:31], v[176:179], v[136:139]
  s_waitcnt lgkmcnt(8)
  v_mfma_f32_32x32x16_bf16 v[32:47], v[188:191], v[180:183], v[32:47]
  ds_read_b128 v[160:163], v5 offset:40960
  ds_read_b128 v[164:167], v5 offset:45056
  v_mfma_f32_32x32x16_bf16 v[48:63], v[188:191], v[184:187], v[48:63]
  ds_read_b64_tr_b16 v[168:169], v11 offset:61440
  ds_read_b64_tr_b16 v[170:171], v11 offset:61952
  v_mfma_f32_32x32x16_bf16 v[64:79], v[192:195], v[180:183], v[64:79]
  ds_read_b64_tr_b16 v[172:173], v13 offset:4096
  v_mfma_f32_32x32x16_bf16 v[80:95], v[192:195], v[184:187], v[80:95]
  ds_read_b64_tr_b16 v[174:175], v13 offset:4608
  ds_read_b64_tr_b16 v[176:177], v13 offset:12288
  v_mfma_f32_32x32x16_bf16 v[96:111], v[180:183], v[196:199], v[96:111]
  ds_read_b64_tr_b16 v[178:179], v13 offset:12800
  v_mfma_f32_32x32x16_bf16 v[112:127], v[184:187], v[196:199], v[112:127]
  s_waitcnt lgkmcnt(8)
  v_mfma_f32_32x32x16_bf16 v[32:47], v[148:151], v[140:143], v[32:47]
  v_mfma_f32_32x32x16_bf16 v[48:63], v[148:151], v[144:147], v[48:63]
  s_waitcnt lgkmcnt(0)
  s_barrier
  v_mfma_f32_32x32x16_bf16 v[64:79], v[152:155], v[140:143], v[64:79]
  ds_read_b128 v[180:183], v6 offset:16384
  ds_read_b128 v[184:187], v6 offset:20480
  v_mfma_f32_32x32x16_bf16 v[80:95], v[152:155], v[144:147], v[80:95]
  ds_read_b64_tr_b16 v[188:189], v12 offset:32768
  ds_read_b64_tr_b16 v[190:191], v12 offset:33280
  v_mfma_f32_32x32x16_bf16 v[96:111], v[140:143], v[156:159], v[96:111]
  ds_read_b64_tr_b16 v[192:193], v12 offset:40960
  ds_read_b64_tr_b16 v[194:195], v12 offset:41472
  v_mfma_f32_32x32x16_bf16 v[112:127], v[144:147], v[156:159], v[112:127]
  ds_read_b64_tr_b16 v[196:197], v12 offset:49152
  ds_read_b64_tr_b16 v[198:199], v12 offset:49664
  v_mfma_f32_16x16x32_bf16 v[128:131], v[28:31], v[148:151], v[128:131]
  v_mfma_f32_16x16x32_bf16 v[132:135], v[28:31], v[152:155], v[132:135]
  v_mfma_f32_16x16x32_bf16 v[136:139], v[28:31], v[156:159], v[136:139]
  s_waitcnt lgkmcnt(8)
  v_mfma_f32_32x32x16_bf16 v[32:47], v[168:171], v[160:163], v[32:47]
  ds_read_b128 v[140:143], v7 offset:16384
  ds_read_b128 v[144:147], v7 offset:20480
  v_mfma_f32_32x32x16_bf16 v[48:63], v[168:171], v[164:167], v[48:63]
  ds_read_b64_tr_b16 v[148:149], v13 offset:32768
  ds_read_b64_tr_b16 v[150:151], v13 offset:33280
  v_mfma_f32_32x32x16_bf16 v[64:79], v[172:175], v[160:163], v[64:79]
  ds_read_b64_tr_b16 v[152:153], v13 offset:40960
  v_mfma_f32_32x32x16_bf16 v[80:95], v[172:175], v[164:167], v[80:95]
  ds_read_b64_tr_b16 v[154:155], v13 offset:41472
  ds_read_b64_tr_b16 v[156:157], v13 offset:49152
  v_mfma_f32_32x32x16_bf16 v[96:111], v[160:163], v[176:179], v[96:111]
  ds_read_b64_tr_b16 v[158:159], v13 offset:49664
  v_mfma_f32_32x32x16_bf16 v[112:127], v[164:167], v[176:179], v[112:127]
  s_waitcnt lgkmcnt(8)
  v_mfma_f32_32x32x16_bf16 v[32:47], v[188:191], v[180:183], v[32:47]
  ds_read_b128 v[160:163], v8 offset:16384
  ds_read_b128 v[164:167], v8 offset:20480
  v_mfma_f32_32x32x16_bf16 v[48:63], v[188:191], v[184:187], v[48:63]
  ds_read_b64_tr_b16 v[168:169], v12 offset:36864
  ds_read_b64_tr_b16 v[170:171], v12 offset:37376
  v_mfma_f32_32x32x16_bf16 v[64:79], v[192:195], v[180:183], v[64:79]
  ds_read_b64_tr_b16 v[172:173], v12 offset:45056
  v_mfma_f32_32x32x16_bf16 v[80:95], v[192:195], v[184:187], v[80:95]
  ds_read_b64_tr_b16 v[174:175], v12 offset:45568
  ds_read_b64_tr_b16 v[176:177], v12 offset:53248
  v_mfma_f32_32x32x16_bf16 v[96:111], v[180:183], v[196:199], v[96:111]
  ds_read_b64_tr_b16 v[178:179], v12 offset:53760
  v_mfma_f32_32x32x16_bf16 v[112:127], v[184:187], v[196:199], v[112:127]
  v_mfma_f32_16x16x32_bf16 v[128:131], v[28:31], v[188:191], v[128:131]
  v_mfma_f32_16x16x32_bf16 v[132:135], v[28:31], v[192:195], v[132:135]
  v_mfma_f32_16x16x32_bf16 v[136:139], v[28:31], v[196:199], v[136:139]
  s_waitcnt lgkmcnt(8)
  v_mfma_f32_32x32x16_bf16 v[32:47], v[148:151], v[140:143], v[32:47]
  ds_read_b128 v[180:183], v9 offset:16384
  ds_read_b128 v[184:187], v9 offset:20480
  v_mfma_f32_32x32x16_bf16 v[48:63], v[148:151], v[144:147], v[48:63]
  ds_read_b64_tr_b16 v[188:189], v13 offset:36864
  ds_read_b64_tr_b16 v[190:191], v13 offset:37376
  v_mfma_f32_32x32x16_bf16 v[64:79], v[152:155], v[140:143], v[64:79]
  ds_read_b64_tr_b16 v[192:193], v13 offset:45056
  v_mfma_f32_32x32x16_bf16 v[80:95], v[152:155], v[144:147], v[80:95]
  ds_read_b64_tr_b16 v[194:195], v13 offset:45568
  ds_read_b64_tr_b16 v[196:197], v13 offset:53248
  v_mfma_f32_32x32x16_bf16 v[96:111], v[140:143], v[156:159], v[96:111]
  ds_read_b64_tr_b16 v[198:199], v13 offset:53760
  v_mfma_f32_32x32x16_bf16 v[112:127], v[144:147], v[156:159], v[112:127]
  s_waitcnt lgkmcnt(8)
  v_mfma_f32_32x32x16_bf16 v[32:47], v[168:171], v[160:163], v[32:47]
  v_mfma_f32_32x32x16_bf16 v[48:63], v[168:171], v[164:167], v[48:63]
  s_waitcnt lgkmcnt(0)
  s_barrier
  v_mfma_f32_32x32x16_bf16 v[64:79], v[172:175], v[160:163], v[64:79]
  ds_read_b128 v[140:143], v2 offset:0
  ds_read_b128 v[144:147], v2 offset:4096
  v_mfma_f32_32x32x16_bf16 v[80:95], v[172:175], v[164:167], v[80:95]
  ds_read_b64_tr_b16 v[148:149], v10 offset:16384
  ds_read_b64_tr_b16 v[150:151], v10 offset:16896
  v_mfma_f32_32x32x16_bf16 v[96:111], v[160:163], v[176:179], v[96:111]
  ds_read_b64_tr_b16 v[152:153], v10 offset:24576
  ds_read_b64_tr_b16 v[154:155], v10 offset:25088
  v_mfma_f32_32x32x16_bf16 v[112:127], v[164:167], v[176:179], v[112:127]
  ds_read_b64_tr_b16 v[156:157], v10 offset:32768
  ds_read_b64_tr_b16 v[158:159], v10 offset:33280
  v_mfma_f32_16x16x32_bf16 v[128:131], v[28:31], v[168:171], v[128:131]
  v_mfma_f32_16x16x32_bf16 v[132:135], v[28:31], v[172:175], v[132:135]
  v_mfma_f32_16x16x32_bf16 v[136:139], v[28:31], v[176:179], v[136:139]
  s_waitcnt lgkmcnt(8)
  v_mfma_f32_32x32x16_bf16 v[32:47], v[188:191], v[180:183], v[32:47]
  ds_read_b128 v[160:163], v3 offset:0
  ds_read_b128 v[164:167], v3 offset:4096
  v_mfma_f32_32x32x16_bf16 v[48:63], v[188:191], v[184:187], v[48:63]
  ds_read_b64_tr_b16 v[168:169], v11 offset:16384
  ds_read_b64_tr_b16 v[170:171], v11 offset:16896
  v_mfma_f32_32x32x16_bf16 v[64:79], v[192:195], v[180:183], v[64:79]
  ds_read_b64_tr_b16 v[172:173], v11 offset:24576
  v_mfma_f32_32x32x16_bf16 v[80:95], v[192:195], v[184:187], v[80:95]
  ds_read_b64_tr_b16 v[174:175], v11 offset:25088
  ds_read_b64_tr_b16 v[176:177], v11 offset:32768
  v_mfma_f32_32x32x16_bf16 v[96:111], v[180:183], v[196:199], v[96:111]
  ds_read_b64_tr_b16 v[178:179], v11 offset:33280
  v_mfma_f32_32x32x16_bf16 v[112:127], v[184:187], v[196:199], v[112:127]
  s_waitcnt lgkmcnt(8)
  v_mfma_f32_32x32x16_bf16 v[32:47], v[148:151], v[140:143], v[32:47]
  ds_read_b128 v[180:183], v4 offset:0
  ds_read_b128 v[184:187], v4 offset:4096
  v_mfma_f32_32x32x16_bf16 v[48:63], v[148:151], v[144:147], v[48:63]
  ds_read_b64_tr_b16 v[188:189], v10 offset:20480
  ds_read_b64_tr_b16 v[190:191], v10 offset:20992
  v_mfma_f32_32x32x16_bf16 v[64:79], v[152:155], v[140:143], v[64:79]
  ds_read_b64_tr_b16 v[192:193], v10 offset:28672
  v_mfma_f32_32x32x16_bf16 v[80:95], v[152:155], v[144:147], v[80:95]
  ds_read_b64_tr_b16 v[194:195], v10 offset:29184
  ds_read_b64_tr_b16 v[196:197], v10 offset:36864
  v_mfma_f32_32x32x16_bf16 v[96:111], v[140:143], v[156:159], v[96:111]
  ds_read_b64_tr_b16 v[198:199], v10 offset:37376
  v_mfma_f32_32x32x16_bf16 v[112:127], v[144:147], v[156:159], v[112:127]
  v_mfma_f32_16x16x32_bf16 v[128:131], v[28:31], v[148:151], v[128:131]
  v_mfma_f32_16x16x32_bf16 v[132:135], v[28:31], v[152:155], v[132:135]
  v_mfma_f32_16x16x32_bf16 v[136:139], v[28:31], v[156:159], v[136:139]
  s_waitcnt lgkmcnt(8)
  v_mfma_f32_32x32x16_bf16 v[32:47], v[168:171], v[160:163], v[32:47]
  ds_read_b128 v[140:143], v5 offset:0
  ds_read_b128 v[144:147], v5 offset:4096
  v_mfma_f32_32x32x16_bf16 v[48:63], v[168:171], v[164:167], v[48:63]
  ds_read_b64_tr_b16 v[148:149], v11 offset:20480
  ds_read_b64_tr_b16 v[150:151], v11 offset:20992
  v_mfma_f32_32x32x16_bf16 v[64:79], v[172:175], v[160:163], v[64:79]
  ds_read_b64_tr_b16 v[152:153], v11 offset:28672
  v_mfma_f32_32x32x16_bf16 v[80:95], v[172:175], v[164:167], v[80:95]
  ds_read_b64_tr_b16 v[154:155], v11 offset:29184
  ds_read_b64_tr_b16 v[156:157], v11 offset:36864
  v_mfma_f32_32x32x16_bf16 v[96:111], v[160:163], v[176:179], v[96:111]
  ds_read_b64_tr_b16 v[158:159], v11 offset:37376
  v_mfma_f32_32x32x16_bf16 v[112:127], v[164:167], v[176:179], v[112:127]
  buffer_load_dwordx4 v[200:203], v19, s[12:15], 0 offen sc1
  s_waitcnt lgkmcnt(8)
  v_mfma_f32_32x32x16_bf16 v[32:47], v[188:191], v[180:183], v[32:47]
  v_mfma_f32_32x32x16_bf16 v[48:63], v[188:191], v[184:187], v[48:63]
  s_waitcnt lgkmcnt(0)
  s_barrier
  v_mfma_f32_32x32x16_bf16 v[64:79], v[192:195], v[180:183], v[64:79]
  ds_read_b128 v[160:163], v2 offset:40960
  ds_read_b128 v[164:167], v2 offset:45056
  v_mfma_f32_32x32x16_bf16 v[80:95], v[192:195], v[184:187], v[80:95]
  ds_read_b64_tr_b16 v[168:169], v10 offset:57344
  ds_read_b64_tr_b16 v[170:171], v10 offset:57856
  v_mfma_f32_32x32x16_bf16 v[96:111], v[180:183], v[196:199], v[96:111]
  ds_read_b64_tr_b16 v[172:173], v12 offset:0
  ds_read_b64_tr_b16 v[174:175], v12 offset:512
  v_mfma_f32_32x32x16_bf16 v[112:127], v[184:187], v[196:199], v[112:127]
  ds_read_b64_tr_b16 v[176:177], v12 offset:8192
  ds_read_b64_tr_b16 v[178:179], v12 offset:8704
  v_mfma_f32_16x16x32_bf16 v[128:131], v[28:31], v[188:191], v[128:131]
  v_mfma_f32_16x16x32_bf16 v[132:135], v[28:31], v[192:195], v[132:135]
  v_mfma_f32_16x16x32_bf16 v[136:139], v[28:31], v[196:199], v[136:139]
  s_waitcnt lgkmcnt(8)
  v_mfma_f32_32x32x16_bf16 v[32:47], v[148:151], v[140:143], v[32:47]
  ds_read_b128 v[180:183], v3 offset:40960
  ds_read_b128 v[184:187], v3 offset:45056
  v_mfma_f32_32x32x16_bf16 v[48:63], v[148:151], v[144:147], v[48:63]
  ds_read_b64_tr_b16 v[188:189], v11 offset:57344
  ds_read_b64_tr_b16 v[190:191], v11 offset:57856
  v_mfma_f32_32x32x16_bf16 v[64:79], v[152:155], v[140:143], v[64:79]
  ds_read_b64_tr_b16 v[192:193], v13 offset:0
  v_mfma_f32_32x32x16_bf16 v[80:95], v[152:155], v[144:147], v[80:95]
  ds_read_b64_tr_b16 v[194:195], v13 offset:512
  ds_read_b64_tr_b16 v[196:197], v13 offset:8192
  v_mfma_f32_32x32x16_bf16 v[96:111], v[140:143], v[156:159], v[96:111]
  ds_read_b64_tr_b16 v[198:199], v13 offset:8704
  v_mfma_f32_32x32x16_bf16 v[112:127], v[144:147], v[156:159], v[112:127]
  s_waitcnt lgkmcnt(8)
  v_mfma_f32_32x32x16_bf16 v[32:47], v[168:171], v[160:163], v[32:47]
  ds_read_b128 v[140:143], v4 offset:40960
  ds_read_b128 v[144:147], v4 offset:45056
  v_mfma_f32_32x32x16_bf16 v[48:63], v[168:171], v[164:167], v[48:63]
  ds_read_b64_tr_b16 v[148:149], v10 offset:61440
  ds_read_b64_tr_b16 v[150:151], v10 offset:61952
  v_mfma_f32_32x32x16_bf16 v[64:79], v[172:175], v[160:163], v[64:79]
  ds_read_b64_tr_b16 v[152:153], v12 offset:4096
  v_mfma_f32_32x32x16_bf16 v[80:95], v[172:175], v[164:167], v[80:95]
  ds_read_b64_tr_b16 v[154:155], v12 offset:4608
  ds_read_b64_tr_b16 v[156:157], v12 offset:12288
  v_mfma_f32_32x32x16_bf16 v[96:111], v[160:163], v[176:179], v[96:111]
  ds_read_b64_tr_b16 v[158:159], v12 offset:12800
  v_mfma_f32_32x32x16_bf16 v[112:127], v[164:167], v[176:179], v[112:127]
  v_mfma_f32_16x16x32_bf16 v[128:131], v[28:31], v[168:171], v[128:131]
  v_mfma_f32_16x16x32_bf16 v[132:135], v[28:31], v[172:175], v[132:135]
  v_mfma_f32_16x16x32_bf16 v[136:139], v[28:31], v[176:179], v[136:139]
  s_waitcnt lgkmcnt(8)
  v_mfma_f32_32x32x16_bf16 v[32:47], v[188:191], v[180:183], v[32:47]
  ds_read_b128 v[160:163], v5 offset:40960
  ds_read_b128 v[164:167], v5 offset:45056
  v_mfma_f32_32x32x16_bf16 v[48:63], v[188:191], v[184:187], v[48:63]
  ds_read_b64_tr_b16 v[168:169], v11 offset:61440
  ds_read_b64_tr_b16 v[170:171], v11 offset:61952
  v_mfma_f32_32x32x16_bf16 v[64:79], v[192:195], v[180:183], v[64:79]
  ds_read_b64_tr_b16 v[172:173], v13 offset:4096
  v_mfma_f32_32x32x16_bf16 v[80:95], v[192:195], v[184:187], v[80:95]
  ds_read_b64_tr_b16 v[174:175], v13 offset:4608
  ds_read_b64_tr_b16 v[176:177], v13 offset:12288
  v_mfma_f32_32x32x16_bf16 v[96:111], v[180:183], v[196:199], v[96:111]
  ds_read_b64_tr_b16 v[178:179], v13 offset:12800
  v_mfma_f32_32x32x16_bf16 v[112:127], v[184:187], v[196:199], v[112:127]
  s_waitcnt lgkmcnt(8)
  v_mfma_f32_32x32x16_bf16 v[32:47], v[148:151], v[140:143], v[32:47]
  v_mfma_f32_32x32x16_bf16 v[48:63], v[148:151], v[144:147], v[48:63]
  s_waitcnt lgkmcnt(0)
  s_barrier
  v_mfma_f32_32x32x16_bf16 v[64:79], v[152:155], v[140:143], v[64:79]
  ds_read_b128 v[180:183], v6 offset:16384
  ds_read_b128 v[184:187], v6 offset:20480
  v_mfma_f32_32x32x16_bf16 v[80:95], v[152:155], v[144:147], v[80:95]
  ds_read_b64_tr_b16 v[188:189], v12 offset:32768
  ds_read_b64_tr_b16 v[190:191], v12 offset:33280
  v_mfma_f32_32x32x16_bf16 v[96:111], v[140:143], v[156:159], v[96:111]
  ds_read_b64_tr_b16 v[192:193], v12 offset:40960
  ds_read_b64_tr_b16 v[194:195], v12 offset:41472
  v_mfma_f32_32x32x16_bf16 v[112:127], v[144:147], v[156:159], v[112:127]
  ds_read_b64_tr_b16 v[196:197], v12 offset:49152
  ds_read_b64_tr_b16 v[198:199], v12 offset:49664
  v_mfma_f32_16x16x32_bf16 v[128:131], v[28:31], v[148:151], v[128:131]
  v_mfma_f32_16x16x32_bf16 v[132:135], v[28:31], v[152:155], v[132:135]
  v_mfma_f32_16x16x32_bf16 v[136:139], v[28:31], v[156:159], v[136:139]
  s_waitcnt lgkmcnt(8)
  v_mfma_f32_32x32x16_bf16 v[32:47], v[168:171], v[160:163], v[32:47]
  ds_read_b128 v[140:143], v7 offset:16384
  ds_read_b128 v[144:147], v7 offset:20480
  v_mfma_f32_32x32x16_bf16 v[48:63], v[168:171], v[164:167], v[48:63]
  ds_read_b64_tr_b16 v[148:149], v13 offset:32768
  ds_read_b64_tr_b16 v[150:151], v13 offset:33280
  v_mfma_f32_32x32x16_bf16 v[64:79], v[172:175], v[160:163], v[64:79]
  ds_read_b64_tr_b16 v[152:153], v13 offset:40960
  v_mfma_f32_32x32x16_bf16 v[80:95], v[172:175], v[164:167], v[80:95]
  ds_read_b64_tr_b16 v[154:155], v13 offset:41472
  ds_read_b64_tr_b16 v[156:157], v13 offset:49152
  v_mfma_f32_32x32x16_bf16 v[96:111], v[160:163], v[176:179], v[96:111]
  ds_read_b64_tr_b16 v[158:159], v13 offset:49664
  v_mfma_f32_32x32x16_bf16 v[112:127], v[164:167], v[176:179], v[112:127]
  s_waitcnt lgkmcnt(8)
  v_mfma_f32_32x32x16_bf16 v[32:47], v[188:191], v[180:183], v[32:47]
  ds_read_b128 v[160:163], v8 offset:16384
  ds_read_b128 v[164:167], v8 offset:20480
  v_mfma_f32_32x32x16_bf16 v[48:63], v[188:191], v[184:187], v[48:63]
  ds_read_b64_tr_b16 v[168:169], v12 offset:36864
  ds_read_b64_tr_b16 v[170:171], v12 offset:37376
  v_mfma_f32_32x32x16_bf16 v[64:79], v[192:195], v[180:183], v[64:79]
  ds_read_b64_tr_b16 v[172:173], v12 offset:45056
  v_mfma_f32_32x32x16_bf16 v[80:95], v[192:195], v[184:187], v[80:95]
  ds_read_b64_tr_b16 v[174:175], v12 offset:45568
  ds_read_b64_tr_b16 v[176:177], v12 offset:53248
  v_mfma_f32_32x32x16_bf16 v[96:111], v[180:183], v[196:199], v[96:111]
  ds_read_b64_tr_b16 v[178:179], v12 offset:53760
  v_mfma_f32_32x32x16_bf16 v[112:127], v[184:187], v[196:199], v[112:127]
  v_mfma_f32_16x16x32_bf16 v[128:131], v[28:31], v[188:191], v[128:131]
  v_mfma_f32_16x16x32_bf16 v[132:135], v[28:31], v[192:195], v[132:135]
  v_mfma_f32_16x16x32_bf16 v[136:139], v[28:31], v[196:199], v[136:139]
  s_waitcnt lgkmcnt(8)
  v_mfma_f32_32x32x16_bf16 v[32:47], v[148:151], v[140:143], v[32:47]
  ds_read_b128 v[180:183], v9 offset:16384
  ds_read_b128 v[184:187], v9 offset:20480
  v_mfma_f32_32x32x16_bf16 v[48:63], v[148:151], v[144:147], v[48:63]
  ds_read_b64_tr_b16 v[188:189], v13 offset:36864
  ds_read_b64_tr_b16 v[190:191], v13 offset:37376
  v_mfma_f32_32x32x16_bf16 v[64:79], v[152:155], v[140:143], v[64:79]
  ds_read_b64_tr_b16 v[192:193], v13 offset:45056
  v_mfma_f32_32x32x16_bf16 v[80:95], v[152:155], v[144:147], v[80:95]
  ds_read_b64_tr_b16 v[194:195], v13 offset:45568
  ds_read_b64_tr_b16 v[196:197], v13 offset:53248
  v_mfma_f32_32x32x16_bf16 v[96:111], v[140:143], v[156:159], v[96:111]
  ds_read_b64_tr_b16 v[198:199], v13 offset:53760
  v_mfma_f32_32x32x16_bf16 v[112:127], v[144:147], v[156:159], v[112:127]
  s_waitcnt lgkmcnt(8)
  v_mfma_f32_32x32x16_bf16 v[32:47], v[168:171], v[160:163], v[32:47]
  v_mfma_f32_32x32x16_bf16 v[48:63], v[168:171], v[164:167], v[48:63]
  s_waitcnt lgkmcnt(0)
  s_barrier
  v_mfma_f32_32x32x16_bf16 v[64:79], v[172:175], v[160:163], v[64:79]
  ds_read_b128 v[140:143], v2 offset:0
  ds_read_b128 v[144:147], v2 offset:4096
  v_mfma_f32_32x32x16_bf16 v[80:95], v[172:175], v[164:167], v[80:95]
  ds_read_b64_tr_b16 v[148:149], v10 offset:16384
  ds_read_b64_tr_b16 v[150:151], v10 offset:16896
  v_mfma_f32_32x32x16_bf16 v[96:111], v[160:163], v[176:179], v[96:111]
  ds_read_b64_tr_b16 v[152:153], v10 offset:24576
  ds_read_b64_tr_b16 v[154:155], v10 offset:25088
  v_mfma_f32_32x32x16_bf16 v[112:127], v[164:167], v[176:179], v[112:127]
  ds_read_b64_tr_b16 v[156:157], v10 offset:32768
  ds_read_b64_tr_b16 v[158:159], v10 offset:33280
  v_mfma_f32_16x16x32_bf16 v[128:131], v[28:31], v[168:171], v[128:131]
  v_mfma_f32_16x16x32_bf16 v[132:135], v[28:31], v[172:175], v[132:135]
  v_mfma_f32_16x16x32_bf16 v[136:139], v[28:31], v[176:179], v[136:139]
  s_waitcnt lgkmcnt(8)
  v_mfma_f32_32x32x16_bf16 v[32:47], v[188:191], v[180:183], v[32:47]
  ds_read_b128 v[160:163], v3 offset:0
  ds_read_b128 v[164:167], v3 offset:4096
  v_mfma_f32_32x32x16_bf16 v[48:63], v[188:191], v[184:187], v[48:63]
  ds_read_b64_tr_b16 v[168:169], v11 offset:16384
  ds_read_b64_tr_b16 v[170:171], v11 offset:16896
  v_mfma_f32_32x32x16_bf16 v[64:79], v[192:195], v[180:183], v[64:79]
  ds_read_b64_tr_b16 v[172:173], v11 offset:24576
  v_mfma_f32_32x32x16_bf16 v[80:95], v[192:195], v[184:187], v[80:95]
  ds_read_b64_tr_b16 v[174:175], v11 offset:25088
  ds_read_b64_tr_b16 v[176:177], v11 offset:32768
  v_mfma_f32_32x32x16_bf16 v[96:111], v[180:183], v[196:199], v[96:111]
  ds_read_b64_tr_b16 v[178:179], v11 offset:33280
  v_mfma_f32_32x32x16_bf16 v[112:127], v[184:187], v[196:199], v[112:127]
  s_waitcnt lgkmcnt(8)
  v_mfma_f32_32x32x16_bf16 v[32:47], v[148:151], v[140:143], v[32:47]
  ds_read_b128 v[180:183], v4 offset:0
  ds_read_b128 v[184:187], v4 offset:4096
  v_mfma_f32_32x32x16_bf16 v[48:63], v[148:151], v[144:147], v[48:63]
  ds_read_b64_tr_b16 v[188:189], v10 offset:20480
  ds_read_b64_tr_b16 v[190:191], v10 offset:20992
  v_mfma_f32_32x32x16_bf16 v[64:79], v[152:155], v[140:143], v[64:79]
  ds_read_b64_tr_b16 v[192:193], v10 offset:28672
  v_mfma_f32_32x32x16_bf16 v[80:95], v[152:155], v[144:147], v[80:95]
  ds_read_b64_tr_b16 v[194:195], v10 offset:29184
  ds_read_b64_tr_b16 v[196:197], v10 offset:36864
  v_mfma_f32_32x32x16_bf16 v[96:111], v[140:143], v[156:159], v[96:111]
  ds_read_b64_tr_b16 v[198:199], v10 offset:37376
  v_mfma_f32_32x32x16_bf16 v[112:127], v[144:147], v[156:159], v[112:127]
  v_mfma_f32_16x16x32_bf16 v[128:131], v[28:31], v[148:151], v[128:131]
  v_mfma_f32_16x16x32_bf16 v[132:135], v[28:31], v[152:155], v[132:135]
  v_mfma_f32_16x16x32_bf16 v[136:139], v[28:31], v[156:159], v[136:139]
  s_waitcnt lgkmcnt(8)
  v_mfma_f32_32x32x16_bf16 v[32:47], v[168:171], v[160:163], v[32:47]
  ds_read_b128 v[140:143], v5 offset:0
  ds_read_b128 v[144:147], v5 offset:4096
  v_mfma_f32_32x32x16_bf16 v[48:63], v[168:171], v[164:167], v[48:63]
  ds_read_b64_tr_b16 v[148:149], v11 offset:20480
  ds_read_b64_tr_b16 v[150:151], v11 offset:20992
  v_mfma_f32_32x32x16_bf16 v[64:79], v[172:175], v[160:163], v[64:79]
  ds_read_b64_tr_b16 v[152:153], v11 offset:28672
  v_mfma_f32_32x32x16_bf16 v[80:95], v[172:175], v[164:167], v[80:95]
  ds_read_b64_tr_b16 v[154:155], v11 offset:29184
  ds_read_b64_tr_b16 v[156:157], v11 offset:36864
  v_mfma_f32_32x32x16_bf16 v[96:111], v[160:163], v[176:179], v[96:111]
  ds_read_b64_tr_b16 v[158:159], v11 offset:37376
  v_mfma_f32_32x32x16_bf16 v[112:127], v[164:167], v[176:179], v[112:127]
  s_waitcnt lgkmcnt(8)
  v_mfma_f32_32x32x16_bf16 v[32:47], v[188:191], v[180:183], v[32:47]
  v_mfma_f32_32x32x16_bf16 v[48:63], v[188:191], v[184:187], v[48:63]
  s_waitcnt lgkmcnt(0)
  s_barrier
  v_mfma_f32_32x32x16_bf16 v[64:79], v[192:195], v[180:183], v[64:79]
  ds_read_b128 v[160:163], v2 offset:40960
  ds_read_b128 v[164:167], v2 offset:45056
  v_mfma_f32_32x32x16_bf16 v[80:95], v[192:195], v[184:187], v[80:95]
  ds_read_b64_tr_b16 v[168:169], v10 offset:57344
  ds_read_b64_tr_b16 v[170:171], v10 offset:57856
  v_mfma_f32_32x32x16_bf16 v[96:111], v[180:183], v[196:199], v[96:111]
  ds_read_b64_tr_b16 v[172:173], v12 offset:0
  ds_read_b64_tr_b16 v[174:175], v12 offset:512
  v_mfma_f32_32x32x16_bf16 v[112:127], v[184:187], v[196:199], v[112:127]
  ds_read_b64_tr_b16 v[176:177], v12 offset:8192
  ds_read_b64_tr_b16 v[178:179], v12 offset:8704
  v_mfma_f32_16x16x32_bf16 v[128:131], v[28:31], v[188:191], v[128:131]
  v_mfma_f32_16x16x32_bf16 v[132:135], v[28:31], v[192:195], v[132:135]
  v_mfma_f32_16x16x32_bf16 v[136:139], v[28:31], v[196:199], v[136:139]
  s_waitcnt lgkmcnt(8)
  v_mfma_f32_32x32x16_bf16 v[32:47], v[148:151], v[140:143], v[32:47]
  ds_read_b128 v[180:183], v3 offset:40960
  ds_read_b128 v[184:187], v3 offset:45056
  v_mfma_f32_32x32x16_bf16 v[48:63], v[148:151], v[144:147], v[48:63]
  ds_read_b64_tr_b16 v[188:189], v11 offset:57344
  ds_read_b64_tr_b16 v[190:191], v11 offset:57856
  v_mfma_f32_32x32x16_bf16 v[64:79], v[152:155], v[140:143], v[64:79]
  ds_read_b64_tr_b16 v[192:193], v13 offset:0
  v_mfma_f32_32x32x16_bf16 v[80:95], v[152:155], v[144:147], v[80:95]
  ds_read_b64_tr_b16 v[194:195], v13 offset:512
  ds_read_b64_tr_b16 v[196:197], v13 offset:8192
  v_mfma_f32_32x32x16_bf16 v[96:111], v[140:143], v[156:159], v[96:111]
  ds_read_b64_tr_b16 v[198:199], v13 offset:8704
  v_mfma_f32_32x32x16_bf16 v[112:127], v[144:147], v[156:159], v[112:127]
  s_waitcnt lgkmcnt(8)
  v_mfma_f32_32x32x16_bf16 v[32:47], v[168:171], v[160:163], v[32:47]
  ds_read_b128 v[140:143], v4 offset:40960
  ds_read_b128 v[144:147], v4 offset:45056
  v_mfma_f32_32x32x16_bf16 v[48:63], v[168:171], v[164:167], v[48:63]
  ds_read_b64_tr_b16 v[148:149], v10 offset:61440
  ds_read_b64_tr_b16 v[150:151], v10 offset:61952
  v_mfma_f32_32x32x16_bf16 v[64:79], v[172:175], v[160:163], v[64:79]
  ds_read_b64_tr_b16 v[152:153], v12 offset:4096
  v_mfma_f32_32x32x16_bf16 v[80:95], v[172:175], v[164:167], v[80:95]
  ds_read_b64_tr_b16 v[154:155], v12 offset:4608
  ds_read_b64_tr_b16 v[156:157], v12 offset:12288
  v_mfma_f32_32x32x16_bf16 v[96:111], v[160:163], v[176:179], v[96:111]
  ds_read_b64_tr_b16 v[158:159], v12 offset:12800
  v_mfma_f32_32x32x16_bf16 v[112:127], v[164:167], v[176:179], v[112:127]
  v_mfma_f32_16x16x32_bf16 v[128:131], v[28:31], v[168:171], v[128:131]
  v_mfma_f32_16x16x32_bf16 v[132:135], v[28:31], v[172:175], v[132:135]
  v_mfma_f32_16x16x32_bf16 v[136:139], v[28:31], v[176:179], v[136:139]
  s_waitcnt lgkmcnt(8)
  v_mfma_f32_32x32x16_bf16 v[32:47], v[188:191], v[180:183], v[32:47]
  ds_read_b128 v[160:163], v5 offset:40960
  ds_read_b128 v[164:167], v5 offset:45056
  v_mfma_f32_32x32x16_bf16 v[48:63], v[188:191], v[184:187], v[48:63]
  ds_read_b64_tr_b16 v[168:169], v11 offset:61440
  ds_read_b64_tr_b16 v[170:171], v11 offset:61952
  v_mfma_f32_32x32x16_bf16 v[64:79], v[192:195], v[180:183], v[64:79]
  ds_read_b64_tr_b16 v[172:173], v13 offset:4096
  v_mfma_f32_32x32x16_bf16 v[80:95], v[192:195], v[184:187], v[80:95]
  ds_read_b64_tr_b16 v[174:175], v13 offset:4608
  ds_read_b64_tr_b16 v[176:177], v13 offset:12288
  v_mfma_f32_32x32x16_bf16 v[96:111], v[180:183], v[196:199], v[96:111]
  ds_read_b64_tr_b16 v[178:179], v13 offset:12800
  v_mfma_f32_32x32x16_bf16 v[112:127], v[184:187], v[196:199], v[112:127]
  s_waitcnt lgkmcnt(0)
  v_mfma_f32_16x16x32_bf16 v[128:131], v[28:31], v[148:151], v[128:131]
  v_mfma_f32_16x16x32_bf16 v[132:135], v[28:31], v[152:155], v[132:135]
  v_mfma_f32_16x16x32_bf16 v[136:139], v[28:31], v[156:159], v[136:139]
  v_mfma_f32_32x32x16_bf16 v[32:47], v[148:151], v[140:143], v[32:47]
  v_mfma_f32_32x32x16_bf16 v[48:63], v[148:151], v[144:147], v[48:63]
  v_mfma_f32_32x32x16_bf16 v[64:79], v[152:155], v[140:143], v[64:79]
  s_mov_b64 exec, 0xffff
  s_nop 1
  ds_write_b32 v14, v128 offset:0
  ds_write_b32 v14, v129 offset:64
  ds_write_b32 v14, v132 offset:128
  ds_write_b32 v14, v133 offset:192
  ds_write_b32 v14, v136 offset:256
  ds_write_b32 v14, v137 offset:320
  s_mov_b64 exec, -1
  v_mfma_f32_32x32x16_bf16 v[80:95], v[152:155], v[144:147], v[80:95]
  v_mfma_f32_32x32x16_bf16 v[96:111], v[140:143], v[156:159], v[96:111]
  v_mfma_f32_32x32x16_bf16 v[112:127], v[144:147], v[156:159], v[112:127]
  v_mfma_f32_32x32x16_bf16 v[32:47], v[168:171], v[160:163], v[32:47]
  v_mfma_f32_32x32x16_bf16 v[48:63], v[168:171], v[164:167], v[48:63]
  s_waitcnt vmcnt(0)
  v_cmp_ne_u32 vcc, s31, v201
  v_cmp_ne_u32 s[32:33], s31, v203
  s_mov_b32 s93, 0
  s_nop 2
  s_or_b64 vcc, vcc, s[32:33]
  s_cbranch_vccz A_st_ok
A_st_spin:
  buffer_load_dwordx4 v[200:203], v19, s[12:15], 0 offen sc1
  s_add_u32 s93, s93, 1
  s_waitcnt vmcnt(0)
  v_cmp_ne_u32 vcc, s31, v201
  v_cmp_ne_u32 s[32:33], s31, v203
  s_nop 3
  s_or_b64 vcc, vcc, s[32:33]
  s_cmp_ge_u32 s93, 100000
  s_cbranch_scc1 A_st_ok
  s_cbranch_vccnz A_st_spin
A_st_ok:
  ds_write_b32 v17, v200
  ds_write_b32 v17, v202 offset:256
  s_waitcnt lgkmcnt(0)
  s_barrier
  v_mfma_f32_32x32x16_bf16 v[64:79], v[172:175], v[160:163], v[64:79]
  v_mfma_f32_32x32x16_bf16 v[80:95], v[172:175], v[164:167], v[80:95]
  v_mfma_f32_32x32x16_bf16 v[96:111], v[160:163], v[176:179], v[96:111]
  v_mfma_f32_32x32x16_bf16 v[112:127], v[164:167], v[176:179], v[112:127]
  ds_read_b128 v[220:223], v15 offset:128
  ds_read_b128 v[224:227], v15 offset:160
  ds_read_b128 v[228:231], v15 offset:192
  ds_read_b128 v[232:235], v15 offset:224
  ds_read_b128 v[140:143], v15 offset:512
  ds_read_b128 v[144:147], v15 offset:544
  ds_read_b128 v[148:151], v15 offset:576
  ds_read_b128 v[152:155], v15 offset:608
  ds_read_b32 v2, v25
  ds_read_b32 v4, v25 offset:256
  ds_read_b32 v6, v25 offset:128
  ds_read_b32 v8, v25 offset:384
  ds_read_b32 v10, v16 offset:256
  ds_read_b32 v11, v16 offset:640
  s_lshl_b32 s28, s94, 1
  s_add_u32 s28, s28, s92
  s_lshl_b32 s86, s95, 2
  s_lshl_b32 s87, s91, 1
  s_add_u32 s86, s86, s87
  s_lshl_b32 s87, s28, 17
  s_lshl_b32 s88, s86, 10
  s_add_u32 s88, s88, s87
  s_add_u32 s88, s88, 2097152
  v_lshl_add_u32 v20, v1, 4, s88
  s_lshl_b32 s88, s86, 11
  s_add_u32 s88, s88, s87
  s_add_u32 s88, s88, 4194304
  v_lshl_add_u32 v21, v1, 4, s88
  s_lshl_b32 s28, s28, 6
  s_add_u32 s28, s28, s86
  s_lshl_b32 s28, s28, 6
  s_add_u32 s28, s28, 10588160
  v_mov_b32 v22, s28
  s_mul_i32 s28, s92, 24576
  s_lshl_b32 s86, s91, 11
  s_add_u32 s87, s28, s86
  s_add_u32 s87, s87, 8192
  v_lshl_add_u32 v26, v1, 4, s87
  s_lshl_b32 s87, s91, 12
  s_add_u32 s87, s87, s28
  s_add_u32 s87, s87, 65536
  v_lshl_add_u32 v27, v1, 4, s87
  s_lshl_b32 s87, s92, 13
  s_add_u32 s87, s87, s86
  s_add_u32 s87, s87, 98304
  v_lshl_add_u32 v28, v1, 4, s87
  s_mov_b32 s90, 65536
  v_mov_b32 v29, s31
  s_waitcnt lgkmcnt(0)
  ds_read_b128 v[156:159], v18 offset:0
  ds_read_b128 v[160:163], v18 offset:32
  ds_read_b128 v[164:167], v18 offset:64
  ds_read_b128 v[168:171], v18 offset:96
  ds_read_b128 v[172:175], v18 offset:256
  ds_read_b128 v[176:179], v18 offset:288
  ds_read_b128 v[180:183], v18 offset:320
  ds_read_b128 v[184:187], v18 offset:352
  v_pk_add_f32 v[220:221], v[220:221], v[140:141]
  v_pk_add_f32 v[222:223], v[222:223], v[142:143]
  v_pk_add_f32 v[224:225], v[224:225], v[144:145]
  v_pk_add_f32 v[226:227], v[226:227], v[146:147]
  v_pk_add_f32 v[228:229], v[228:229], v[148:149]
  v_pk_add_f32 v[230:231], v[230:231], v[150:151]
  v_pk_add_f32 v[232:233], v[232:233], v[152:153]
  v_pk_add_f32 v[234:235], v[234:235], v[154:155]
  v_add_f32 v10, v10, v11
  v_pk_fma_f32 v[64:65], v[220:221], v[2:3], v[64:65] op_sel_hi:[1,0,1]
  v_pk_fma_f32 v[66:67], v[222:223], v[2:3], v[66:67] op_sel_hi:[1,0,1]
  v_pk_fma_f32 v[68:69], v[224:225], v[2:3], v[68:69] op_sel_hi:[1,0,1]
  v_pk_fma_f32 v[70:71], v[226:227], v[2:3], v[70:71] op_sel_hi:[1,0,1]
  v_pk_fma_f32 v[72:73], v[228:229], v[2:3], v[72:73] op_sel_hi:[1,0,1]
  v_pk_fma_f32 v[74:75], v[230:231], v[2:3], v[74:75] op_sel_hi:[1,0,1]
  v_pk_fma_f32 v[76:77], v[232:233], v[2:3], v[76:77] op_sel_hi:[1,0,1]
  v_pk_fma_f32 v[78:79], v[234:235], v[2:3], v[78:79] op_sel_hi:[1,0,1]
  v_pk_mul_f32 v[64:65], v[64:65], v[4:5] op_sel_hi:[1,0]
  v_pk_mul_f32 v[66:67], v[66:67], v[4:5] op_sel_hi:[1,0]
  v_pk_mul_f32 v[68:69], v[68:69], v[4:5] op_sel_hi:[1,0]
  v_pk_mul_f32 v[70:71], v[70:71], v[4:5] op_sel_hi:[1,0]
  v_pk_mul_f32 v[72:73], v[72:73], v[4:5] op_sel_hi:[1,0]
  v_pk_mul_f32 v[74:75], v[74:75], v[4:5] op_sel_hi:[1,0]
  v_pk_mul_f32 v[76:77], v[76:77], v[4:5] op_sel_hi:[1,0]
  v_pk_mul_f32 v[78:79], v[78:79], v[4:5] op_sel_hi:[1,0]
  v_cvt_pk_bf16_f32 v64, v64, v65
  v_cvt_pk_bf16_f32 v65, v66, v67
  v_cvt_pk_bf16_f32 v66, v68, v69
  v_cvt_pk_bf16_f32 v67, v70, v71
  v_cvt_pk_bf16_f32 v68, v72, v73
  v_cvt_pk_bf16_f32 v69, v74, v75
  v_cvt_pk_bf16_f32 v70, v76, v77
  v_cvt_pk_bf16_f32 v71, v78, v79
  buffer_store_dwordx4 v[64:67], v20, s[12:15], 0 offen offset:0 sc1
  buffer_store_dwordx4 v[68:71], v20, s[12:15], s90 offen offset:0 sc1
  v_pk_fma_f32 v[80:81], v[220:221], v[6:7], v[80:81] op_sel_hi:[1,0,1]
  v_pk_fma_f32 v[82:83], v[222:223], v[6:7], v[82:83] op_sel_hi:[1,0,1]
  v_pk_fma_f32 v[84:85], v[224:225], v[6:7], v[84:85] op_sel_hi:[1,0,1]
  v_pk_fma_f32 v[86:87], v[226:227], v[6:7], v[86:87] op_sel_hi:[1,0,1]
  v_pk_fma_f32 v[88:89], v[228:229], v[6:7], v[88:89] op_sel_hi:[1,0,1]
  v_pk_fma_f32 v[90:91], v[230:231], v[6:7], v[90:91] op_sel_hi:[1,0,1]
  v_pk_fma_f32 v[92:93], v[232:233], v[6:7], v[92:93] op_sel_hi:[1,0,1]
  v_pk_fma_f32 v[94:95], v[234:235], v[6:7], v[94:95] op_sel_hi:[1,0,1]
  v_pk_mul_f32 v[80:81], v[80:81], v[8:9] op_sel_hi:[1,0]
  v_pk_mul_f32 v[82:83], v[82:83], v[8:9] op_sel_hi:[1,0]
  v_pk_mul_f32 v[84:85], v[84:85], v[8:9] op_sel_hi:[1,0]
  v_pk_mul_f32 v[86:87], v[86:87], v[8:9] op_sel_hi:[1,0]
  v_pk_mul_f32 v[88:89], v[88:89], v[8:9] op_sel_hi:[1,0]
  v_pk_mul_f32 v[90:91], v[90:91], v[8:9] op_sel_hi:[1,0]
  v_pk_mul_f32 v[92:93], v[92:93], v[8:9] op_sel_hi:[1,0]
  v_pk_mul_f32 v[94:95], v[94:95], v[8:9] op_sel_hi:[1,0]
  v_cvt_pk_bf16_f32 v80, v80, v81
  v_cvt_pk_bf16_f32 v81, v82, v83
  v_cvt_pk_bf16_f32 v82, v84, v85
  v_cvt_pk_bf16_f32 v83, v86, v87
  v_cvt_pk_bf16_f32 v84, v88, v89
  v_cvt_pk_bf16_f32 v85, v90, v91
  v_cvt_pk_bf16_f32 v86, v92, v93
  v_cvt_pk_bf16_f32 v87, v94, v95
  buffer_store_dwordx4 v[80:83], v20, s[12:15], 0 offen offset:1024 sc1
  buffer_store_dwordx4 v[84:87], v20, s[12:15], s90 offen offset:1024 sc1
  s_waitcnt lgkmcnt(0)
  v_pk_fma_f32 v[96:97], v[156:157], v[10:11], v[96:97] op_sel_hi:[1,0,1]
  v_pk_fma_f32 v[98:99], v[158:159], v[10:11], v[98:99] op_sel_hi:[1,0,1]
  v_pk_fma_f32 v[100:101], v[160:161], v[10:11], v[100:101] op_sel_hi:[1,0,1]
  v_pk_fma_f32 v[102:103], v[162:163], v[10:11], v[102:103] op_sel_hi:[1,0,1]
  v_pk_fma_f32 v[104:105], v[164:165], v[10:11], v[104:105] op_sel_hi:[1,0,1]
  v_pk_fma_f32 v[106:107], v[166:167], v[10:11], v[106:107] op_sel_hi:[1,0,1]
  v_pk_fma_f32 v[108:109], v[168:169], v[10:11], v[108:109] op_sel_hi:[1,0,1]
  v_pk_fma_f32 v[110:111], v[170:171], v[10:11], v[110:111] op_sel_hi:[1,0,1]
  v_pk_mul_f32 v[96:97], v[96:97], v[172:173]
  v_pk_mul_f32 v[98:99], v[98:99], v[174:175]
  v_pk_mul_f32 v[100:101], v[100:101], v[176:177]
  v_pk_mul_f32 v[102:103], v[102:103], v[178:179]
  v_pk_mul_f32 v[104:105], v[104:105], v[180:181]
  v_pk_mul_f32 v[106:107], v[106:107], v[182:183]
  v_pk_mul_f32 v[108:109], v[108:109], v[184:185]
  v_pk_mul_f32 v[110:111], v[110:111], v[186:187]
  v_cvt_pk_bf16_f32 v96, v96, v97
  v_cvt_pk_bf16_f32 v97, v98, v99
  v_cvt_pk_bf16_f32 v98, v100, v101
  v_cvt_pk_bf16_f32 v99, v102, v103
  v_cvt_pk_bf16_f32 v100, v104, v105
  v_cvt_pk_bf16_f32 v101, v106, v107
  v_cvt_pk_bf16_f32 v102, v108, v109
  v_cvt_pk_bf16_f32 v103, v110, v111
  ds_read_b128 v[156:159], v18 offset:128
  ds_read_b128 v[160:163], v18 offset:160
  ds_read_b128 v[164:167], v18 offset:192
  ds_read_b128 v[168:171], v18 offset:224
  ds_read_b128 v[172:175], v18 offset:384
  ds_read_b128 v[176:179], v18 offset:416
  ds_read_b128 v[180:183], v18 offset:448
  ds_read_b128 v[184:187], v18 offset:480
  buffer_store_dwordx4 v[96:99], v21, s[12:15], 0 offen offset:0 sc1
  buffer_store_dwordx4 v[100:103], v21, s[12:15], 0 offen offset:1024 sc1
  ds_write_b128 v26, v[64:67] offset:0
  ds_write_b128 v26, v[68:71] offset:12288
  ds_write_b128 v26, v[80:83] offset:1024
  ds_write_b128 v26, v[84:87] offset:13312
  s_waitcnt lgkmcnt(0)
  v_pk_fma_f32 v[112:113], v[156:157], v[10:11], v[112:113] op_sel_hi:[1,0,1]
  v_pk_fma_f32 v[114:115], v[158:159], v[10:11], v[114:115] op_sel_hi:[1,0,1]
  v_pk_fma_f32 v[116:117], v[160:161], v[10:11], v[116:117] op_sel_hi:[1,0,1]
  v_pk_fma_f32 v[118:119], v[162:163], v[10:11], v[118:119] op_sel_hi:[1,0,1]
  v_pk_fma_f32 v[120:121], v[164:165], v[10:11], v[120:121] op_sel_hi:[1,0,1]
  v_pk_fma_f32 v[122:123], v[166:167], v[10:11], v[122:123] op_sel_hi:[1,0,1]
  v_pk_fma_f32 v[124:125], v[168:169], v[10:11], v[124:125] op_sel_hi:[1,0,1]
  v_pk_fma_f32 v[126:127], v[170:171], v[10:11], v[126:127] op_sel_hi:[1,0,1]
  v_pk_mul_f32 v[112:113], v[112:113], v[172:173]
  v_pk_mul_f32 v[114:115], v[114:115], v[174:175]
  v_pk_mul_f32 v[116:117], v[116:117], v[176:177]
  v_pk_mul_f32 v[118:119], v[118:119], v[178:179]
  v_pk_mul_f32 v[120:121], v[120:121], v[180:181]
  v_pk_mul_f32 v[122:123], v[122:123], v[182:183]
  v_pk_mul_f32 v[124:125], v[124:125], v[184:185]
  v_pk_mul_f32 v[126:127], v[126:127], v[186:187]
  v_cvt_pk_bf16_f32 v112, v112, v113
  v_cvt_pk_bf16_f32 v113, v114, v115
  v_cvt_pk_bf16_f32 v114, v116, v117
  v_cvt_pk_bf16_f32 v115, v118, v119
  v_cvt_pk_bf16_f32 v116, v120, v121
  v_cvt_pk_bf16_f32 v117, v122, v123
  v_cvt_pk_bf16_f32 v118, v124, v125
  v_cvt_pk_bf16_f32 v119, v126, v127
  ds_read_b128 v[204:207], v15 offset:0
  ds_read_b128 v[208:211], v15 offset:32
  ds_read_b128 v[212:215], v15 offset:64
  ds_read_b128 v[216:219], v15 offset:96
  ds_read_b128 v[140:143], v15 offset:384
  ds_read_b128 v[144:147], v15 offset:416
  ds_read_b128 v[148:151], v15 offset:448
  ds_read_b128 v[152:155], v15 offset:480
  buffer_store_dwordx4 v[112:115], v21, s[12:15], 0 offen offset:2048 sc1
  buffer_store_dwordx4 v[116:119], v21, s[12:15], 0 offen offset:3072 sc1
  ds_write_b128 v27, v[96:99] offset:0
  ds_write_b128 v27, v[100:103] offset:1024
  ds_write_b128 v27, v[112:115] offset:2048
  ds_write_b128 v27, v[116:119] offset:3072
  v_mul_f32 v4, 0x3eb8aa3b, v4
  v_mul_f32 v8, 0x3eb8aa3b, v8
  s_waitcnt lgkmcnt(4)
  v_pk_add_f32 v[204:205], v[204:205], v[140:141]
  v_pk_add_f32 v[206:207], v[206:207], v[142:143]
  v_pk_add_f32 v[208:209], v[208:209], v[144:145]
  v_pk_add_f32 v[210:211], v[210:211], v[146:147]
  v_pk_add_f32 v[212:213], v[212:213], v[148:149]
  v_pk_add_f32 v[214:215], v[214:215], v[150:151]
  v_pk_add_f32 v[216:217], v[216:217], v[152:153]
  v_pk_add_f32 v[218:219], v[218:219], v[154:155]
  v_pk_fma_f32 v[32:33], v[204:205], v[2:3], v[32:33] op_sel_hi:[1,0,1]
  v_pk_fma_f32 v[34:35], v[206:207], v[2:3], v[34:35] op_sel_hi:[1,0,1]
  v_pk_fma_f32 v[36:37], v[208:209], v[2:3], v[36:37] op_sel_hi:[1,0,1]
  v_pk_fma_f32 v[38:39], v[210:211], v[2:3], v[38:39] op_sel_hi:[1,0,1]
  v_pk_fma_f32 v[40:41], v[212:213], v[2:3], v[40:41] op_sel_hi:[1,0,1]
  v_pk_fma_f32 v[42:43], v[214:215], v[2:3], v[42:43] op_sel_hi:[1,0,1]
  v_pk_fma_f32 v[44:45], v[216:217], v[2:3], v[44:45] op_sel_hi:[1,0,1]
  v_pk_fma_f32 v[46:47], v[218:219], v[2:3], v[46:47] op_sel_hi:[1,0,1]
  v_pk_mul_f32 v[32:33], v[32:33], v[4:5] op_sel_hi:[1,0]
  v_pk_mul_f32 v[34:35], v[34:35], v[4:5] op_sel_hi:[1,0]
  v_pk_mul_f32 v[36:37], v[36:37], v[4:5] op_sel_hi:[1,0]
  v_pk_mul_f32 v[38:39], v[38:39], v[4:5] op_sel_hi:[1,0]
  v_pk_mul_f32 v[40:41], v[40:41], v[4:5] op_sel_hi:[1,0]
  v_pk_mul_f32 v[42:43], v[42:43], v[4:5] op_sel_hi:[1,0]
  v_pk_mul_f32 v[44:45], v[44:45], v[4:5] op_sel_hi:[1,0]
  v_pk_mul_f32 v[46:47], v[46:47], v[4:5] op_sel_hi:[1,0]
  v_cvt_pk_bf16_f32 v32, v32, v33
  v_cvt_pk_bf16_f32 v33, v34, v35
  v_cvt_pk_bf16_f32 v34, v36, v37
  v_cvt_pk_bf16_f32 v35, v38, v39
  v_cvt_pk_bf16_f32 v36, v40, v41
  v_cvt_pk_bf16_f32 v37, v42, v43
  v_cvt_pk_bf16_f32 v38, v44, v45
  v_cvt_pk_bf16_f32 v39, v46, v47
  ds_write_b128 v28, v[32:35] offset:0
  ds_write_b128 v28, v[36:39] offset:4096
  v_pk_fma_f32 v[48:49], v[204:205], v[6:7], v[48:49] op_sel_hi:[1,0,1]
  v_pk_fma_f32 v[50:51], v[206:207], v[6:7], v[50:51] op_sel_hi:[1,0,1]
  v_pk_fma_f32 v[52:53], v[208:209], v[6:7], v[52:53] op_sel_hi:[1,0,1]
  v_pk_fma_f32 v[54:55], v[210:211], v[6:7], v[54:55] op_sel_hi:[1,0,1]
  v_pk_fma_f32 v[56:57], v[212:213], v[6:7], v[56:57] op_sel_hi:[1,0,1]
  v_pk_fma_f32 v[58:59], v[214:215], v[6:7], v[58:59] op_sel_hi:[1,0,1]
  v_pk_fma_f32 v[60:61], v[216:217], v[6:7], v[60:61] op_sel_hi:[1,0,1]
  v_pk_fma_f32 v[62:63], v[218:219], v[6:7], v[62:63] op_sel_hi:[1,0,1]
  v_pk_mul_f32 v[48:49], v[48:49], v[8:9] op_sel_hi:[1,0]
  v_pk_mul_f32 v[50:51], v[50:51], v[8:9] op_sel_hi:[1,0]
  v_pk_mul_f32 v[52:53], v[52:53], v[8:9] op_sel_hi:[1,0]
  v_pk_mul_f32 v[54:55], v[54:55], v[8:9] op_sel_hi:[1,0]
  v_pk_mul_f32 v[56:57], v[56:57], v[8:9] op_sel_hi:[1,0]
  v_pk_mul_f32 v[58:59], v[58:59], v[8:9] op_sel_hi:[1,0]
  v_pk_mul_f32 v[60:61], v[60:61], v[8:9] op_sel_hi:[1,0]
  v_pk_mul_f32 v[62:63], v[62:63], v[8:9] op_sel_hi:[1,0]
  v_cvt_pk_bf16_f32 v48, v48, v49
  v_cvt_pk_bf16_f32 v49, v50, v51
  v_cvt_pk_bf16_f32 v50, v52, v53
  v_cvt_pk_bf16_f32 v51, v54, v55
  v_cvt_pk_bf16_f32 v52, v56, v57
  v_cvt_pk_bf16_f32 v53, v58, v59
  v_cvt_pk_bf16_f32 v54, v60, v61
  v_cvt_pk_bf16_f32 v55, v62, v63
  ds_write_b128 v28, v[48:51] offset:1024
  ds_write_b128 v28, v[52:55] offset:5120
  v_mov_b32 v252, v22
  v_mov_b32 v253, v29
  s_waitcnt vmcnt(0)
  s_mov_b64 exec, 1
  buffer_store_dword v253, v252, s[12:15], 0 offen sc1
  s_mov_b64 exec, -1
A_attn:
  v_lshlrev_b32 v3, 4, v1
  s_lshr_b32 s91, s24, 1
  s_and_b32 s9, s3, 1
  s_cmp_lt_u32 s3, 4
  s_cselect_b32 s28, 2, 0
  s_add_u32 s9, s9, s28
  s_lshl_b32 s92, s95, 2
  s_add_u32 s92, s92, s9
  s_min_u32 s90, s92, 8
  s_mov_b32 s89, 0
  v_and_b32 v4, 31, v1
  v_lshrrev_b32 v5, 5, v1
  v_lshlrev_b32 v5, 2, v5
  v_sub_u32 v4, v4, v5
  v_cmp_le_i32 s[32:33], 0, v4
  v_cmp_le_i32 s[34:35], 1, v4
  v_cmp_le_i32 s[36:37], 2, v4
  v_cmp_le_i32 s[38:39], 3, v4
  v_cmp_le_i32 s[40:41], 8, v4
  v_cmp_le_i32 s[42:43], 9, v4
  v_cmp_le_i32 s[44:45], 10, v4
  v_cmp_le_i32 s[46:47], 11, v4
  v_cmp_le_i32 s[48:49], 16, v4
  v_cmp_le_i32 s[50:51], 17, v4
  v_cmp_le_i32 s[52:53], 18, v4
  v_cmp_le_i32 s[54:55], 19, v4
  v_cmp_le_i32 s[56:57], 24, v4
  v_cmp_le_i32 s[58:59], 25, v4
  v_cmp_le_i32 s[60:61], 26, v4
  v_cmp_le_i32 s[62:63], 27, v4
  v_mov_b32 v6, 0xf149f2ca
  s_mul_i32 s28, s91, 24576
  s_lshl_b32 s86, s9, 10
  s_add_u32 s87, s28, s86
  v_add_u32 v4, s87, v3
  s_add_u32 s87, s87, s86
  s_add_u32 s87, s87, 49152
  v_add_u32 v5, s87, v3
  s_lshl_b32 s87, s91, 13
  s_add_u32 s87, s87, s86
  s_add_u32 s87, s87, 98304
  v_add_u32 v7, s87, v3
  s_mov_b32 s4, 0x0000ffff
  s_mov_b32 s5, 0x0000ffff
  s_mov_b32 s6, 0xffff0000
  s_mov_b32 s7, 0xffff0000
  v_mov_b32 v176, 0x3f803f80
  v_mov_b32 v177, 0x3f803f80
  v_mov_b32 v178, 0x3f803f80
  v_mov_b32 v179, 0x3f803f80
  v_mov_b32 v180, 0x3f803f80
  v_mov_b32 v181, 0x3f803f80
  v_mov_b32 v182, 0x3f803f80
  v_mov_b32 v183, 0x3f803f80
  v_mov_b32 v184, 0x3f803f80
  v_mov_b32 v185, 0x3f803f80
  v_mov_b32 v186, 0x3f803f80
  v_mov_b32 v187, 0x3f803f80
  v_mov_b32 v188, 0x3f803f80
  v_mov_b32 v189, 0x3f803f80
  v_mov_b32 v190, 0x3f803f80
  v_mov_b32 v191, 0x3f803f80
  v_mov_b32 v192, 0x3f803f80
  v_mov_b32 v193, 0x3f803f80
  v_mov_b32 v194, 0x3f803f80
  v_mov_b32 v195, 0x3f803f80
  v_mov_b32 v196, 0x3f803f80
  v_mov_b32 v197, 0x3f803f80
  v_mov_b32 v198, 0x3f803f80
  v_mov_b32 v199, 0x3f803f80
  v_mov_b32 v200, 0x3f803f80
  v_mov_b32 v201, 0x3f803f80
  v_mov_b32 v202, 0x3f803f80
  v_mov_b32 v203, 0x3f803f80
  v_mov_b32 v204, 0x3f803f80
  v_mov_b32 v205, 0x3f803f80
  v_mov_b32 v206, 0x3f803f80
  v_mov_b32 v207, 0x3f803f80
  s_mov_b32 s16, s76
  s_mov_b32 s17, s77
  s_mov_b32 s18, 5636096
  s_mov_b32 s19, 0x00020000
  s_mov_b32 s20, s68
  s_mov_b32 s21, s69
  s_mov_b32 s22, 524288
  s_mov_b32 s23, 0x00020000
  s_lshl_b32 s28, s27, 3
  s_add_u32 s28, s28, s3
  v_lshrrev_b32 v248, 3, v1
  v_lshlrev_b32 v248, 12, v248
  v_and_b32 v250, 7, v1
  v_lshl_add_u32 v248, v250, 7, v248
  s_lshl_b32 s86, s28, 15
  s_lshl_b32 s87, s25, 10
  s_add_u32 s86, s86, s87
  v_add_u32 v248, s86, v248
  v_add_u32 v249, 4194304, v248
  v_lshrrev_b32 v250, 2, v1
  v_lshlrev_b32 v250, 10, v250
  v_and_b32 v224, 3, v1
  v_lshl_add_u32 v250, v224, 7, v250
  s_sub_u32 s86, s28, 44
  s_lshl_b32 s86, s86, 14
  s_lshl_b32 s87, s26, 9
  s_add_u32 s86, s86, s87
  s_and_b32 s86, s86, 0x7fffffff
  v_add_u32 v250, s86, v250
  s_waitcnt lgkmcnt(0)
  s_barrier
  ds_read_b128 v[8:11], v7
  ds_read_b128 v[12:15], v7 offset:4096
  s_mov_b32 s8, 99
  s_mov_b32 s10, 0
  v_mov_b32 v212, 126976
  v_mov_b32 v213, 1
  s_lshl1_add_u32 s86, s94, s91
  s_lshl_b32 s87, s95, 2
  s_lshl_b32 s88, s86, 6
  s_add_u32 s88, s88, s87
  s_lshl_b32 s88, s88, 6
  s_add_u32 s88, s88, 10587648
  v_lshl_add_u32 v2, v1, 7, s88
  s_cmp_eq_u32 s95, 0
  s_cbranch_scc1 A_h_done
  s_mov_b32 s8, s9
  s_cmp_lt_u32 s3, 4
  s_cbranch_scc1 A_p1
  s_mov_b32 s10, 1
  s_cmp_eq_u32 s95, 1
  s_cselect_b32 exec_lo, 12, 15
  s_mov_b32 exec_hi, 0
  buffer_load_dword v214, v2, s[12:15], 0 offen sc1
  s_mov_b64 exec, -1
  s_setprio 1
  s_branch A_p1
A_h_done:
  s_cmp_lt_u32 s3, 4
  s_cbranch_scc1 A_p1
  s_lshl_b32 s28, s24, 12
  s_add_u32 m0, s28, 131072
  s_mul_i32 s96, s97, 524288
  buffer_load_dwordx4 v240, s[16:19], s96 offen offset:0 lds
  buffer_load_dwordx4 v241, s[16:19], s96 offen offset:1024 lds
  buffer_load_dwordx4 v242, s[16:19], s96 offen offset:2048 lds
  buffer_load_dwordx4 v243, s[16:19], s96 offen offset:3072 lds
  s_lshl_b32 s28, s24, 12
  s_add_u32 m0, s28, 147456
  s_add_u32 s96, s96, 524288
  s_cmp_eq_u32 s96, 5767168
  s_cselect_b32 s96, 0, s96
  buffer_load_dwordx4 v240, s[16:19], s96 offen offset:0 lds
  buffer_load_dwordx4 v241, s[16:19], s96 offen offset:1024 lds
  buffer_load_dwordx4 v242, s[16:19], s96 offen offset:2048 lds
  buffer_load_dwordx4 v243, s[16:19], s96 offen offset:3072 lds
A_p1:
  ds_read_b128 v[144:147], v4 offset:8192
  ds_read_b128 v[148:151], v4 offset:20480
  ds_read_b128 v[152:155], v4 offset:7168
  ds_read_b128 v[156:159], v4 offset:19456
  v_cndmask_b32 v16, v6, 0, s[32:33]
  v_cndmask_b32 v17, v6, 0, s[34:35]
  v_cndmask_b32 v18, v6, 0, s[36:37]
  v_cndmask_b32 v19, v6, 0, s[38:39]
  v_cndmask_b32 v20, v6, 0, s[40:41]
  v_cndmask_b32 v21, v6, 0, s[42:43]
  v_cndmask_b32 v22, v6, 0, s[44:45]
  v_cndmask_b32 v23, v6, 0, s[46:47]
  v_cndmask_b32 v24, v6, 0, s[48:49]
  v_cndmask_b32 v25, v6, 0, s[50:51]
  v_cndmask_b32 v26, v6, 0, s[52:53]
  v_cndmask_b32 v27, v6, 0, s[54:55]
  v_cndmask_b32 v28, v6, 0, s[56:57]
  v_cndmask_b32 v29, v6, 0, s[58:59]
  v_cndmask_b32 v30, v6, 0, s[60:61]
  v_cndmask_b32 v31, v6, 0, s[62:63]
  v_mov_b32 v208, v6
  v_mov_b32 v209, v6
  s_waitcnt lgkmcnt(0)
  v_mfma_f32_32x32x16_bf16 v[80:95], v[144:147], v[8:11], v[16:31]
  v_mfma_f32_32x32x16_bf16 v[96:111], v[148:151], v[12:15], v[16:31]
  v_mov_b32 v48, 0
  v_mov_b32 v49, 0
  v_mov_b32 v50, 0
  v_mov_b32 v51, 0
  v_mov_b32 v52, 0
  v_mov_b32 v53, 0
  v_mov_b32 v54, 0
  v_mov_b32 v55, 0
  v_mov_b32 v56, 0
  v_mov_b32 v57, 0
  v_mov_b32 v58, 0
  v_mov_b32 v59, 0
  v_mov_b32 v60, 0
  v_mov_b32 v61, 0
  v_mov_b32 v62, 0
  v_mov_b32 v63, 0
  v_mov_b32 v64, 0
  v_mov_b32 v65, 0
  v_mov_b32 v66, 0
  v_mov_b32 v67, 0
  v_mov_b32 v68, 0
  v_mov_b32 v69, 0
  v_mov_b32 v70, 0
  v_mov_b32 v71, 0
  v_mov_b32 v72, 0
  v_mov_b32 v73, 0
  v_mov_b32 v74, 0
  v_mov_b32 v75, 0
  v_mov_b32 v76, 0
  v_mov_b32 v77, 0
  v_mov_b32 v78, 0
  v_mov_b32 v79, 0
  s_cmp_lt_u32 s89, 1
  s_cbranch_scc1 A_p1_last0
  s_waitcnt lgkmcnt(0)
  v_mfma_f32_32x32x16_bf16 v[112:127], v[152:155], v[8:11], 0
  v_mfma_f32_32x32x16_bf16 v[128:143], v[156:159], v[12:15], 0
  ds_read_b128 v[144:147], v4 offset:6144
  ds_read_b128 v[148:151], v4 offset:18432
  v_max3_f32 v208, v80, v81, v208
  v_max3_f32 v209, v96, v97, v209
  v_max3_f32 v208, v82, v83, v208
  v_max3_f32 v209, v98, v99, v209
  v_max3_f32 v208, v84, v85, v208
  v_max3_f32 v209, v100, v101, v209
  v_max3_f32 v208, v86, v87, v208
  v_max3_f32 v209, v102, v103, v209
  v_max3_f32 v208, v88, v89, v208
  v_max3_f32 v209, v104, v105, v209
  v_max3_f32 v208, v90, v91, v208
  v_max3_f32 v209, v106, v107, v209
  v_max3_f32 v208, v92, v93, v208
  v_max3_f32 v209, v108, v109, v209
  v_max3_f32 v208, v94, v95, v208
  v_max3_f32 v209, v110, v111, v209
  s_cmp_lt_u32 s89, 2
  s_cbranch_scc1 A_p1_last1
  s_waitcnt lgkmcnt(0)
  v_mfma_f32_32x32x16_bf16 v[80:95], v[144:147], v[8:11], 0
  v_mfma_f32_32x32x16_bf16 v[96:111], v[148:151], v[12:15], 0
  ds_read_b128 v[152:155], v4 offset:5120
  ds_read_b128 v[156:159], v4 offset:17408
  v_max3_f32 v208, v112, v113, v208
  v_max3_f32 v209, v128, v129, v209
  v_max3_f32 v208, v114, v115, v208
  v_max3_f32 v209, v130, v131, v209
  v_max3_f32 v208, v116, v117, v208
  v_max3_f32 v209, v132, v133, v209
  v_max3_f32 v208, v118, v119, v208
  v_max3_f32 v209, v134, v135, v209
  v_max3_f32 v208, v120, v121, v208
  v_max3_f32 v209, v136, v137, v209
  v_max3_f32 v208, v122, v123, v208
  v_max3_f32 v209, v138, v139, v209
  v_max3_f32 v208, v124, v125, v208
  v_max3_f32 v209, v140, v141, v209
  v_max3_f32 v208, v126, v127, v208
  v_max3_f32 v209, v142, v143, v209
  s_cmp_lt_u32 s89, 3
  s_cbranch_scc1 A_p1_last0
  s_waitcnt lgkmcnt(0)
  v_mfma_f32_32x32x16_bf16 v[112:127], v[152:155], v[8:11], 0
  v_mfma_f32_32x32x16_bf16 v[128:143], v[156:159], v[12:15], 0
  ds_read_b128 v[144:147], v4 offset:4096
  ds_read_b128 v[148:151], v4 offset:16384
  v_max3_f32 v208, v80, v81, v208
  v_max3_f32 v209, v96, v97, v209
  v_max3_f32 v208, v82, v83, v208
  v_max3_f32 v209, v98, v99, v209
  v_max3_f32 v208, v84, v85, v208
  v_max3_f32 v209, v100, v101, v209
  v_max3_f32 v208, v86, v87, v208
  v_max3_f32 v209, v102, v103, v209
  v_max3_f32 v208, v88, v89, v208
  v_max3_f32 v209, v104, v105, v209
  v_max3_f32 v208, v90, v91, v208
  v_max3_f32 v209, v106, v107, v209
  v_max3_f32 v208, v92, v93, v208
  v_max3_f32 v209, v108, v109, v209
  v_max3_f32 v208, v94, v95, v208
  v_max3_f32 v209, v110, v111, v209
  s_cmp_lt_u32 s89, 4
  s_cbranch_scc1 A_p1_last1
  s_waitcnt lgkmcnt(0)
  v_mfma_f32_32x32x16_bf16 v[80:95], v[144:147], v[8:11], 0
  v_mfma_f32_32x32x16_bf16 v[96:111], v[148:151], v[12:15], 0
  ds_read_b128 v[152:155], v4 offset:3072
  ds_read_b128 v[156:159], v4 offset:15360
  v_max3_f32 v208, v112, v113, v208
  v_max3_f32 v209, v128, v129, v209
  v_max3_f32 v208, v114, v115, v208
  v_max3_f32 v209, v130, v131, v209
  v_max3_f32 v208, v116, v117, v208
  v_max3_f32 v209, v132, v133, v209
  v_max3_f32 v208, v118, v119, v208
  v_max3_f32 v209, v134, v135, v209
  v_max3_f32 v208, v120, v121, v208
  v_max3_f32 v209, v136, v137, v209
  v_max3_f32 v208, v122, v123, v208
  v_max3_f32 v209, v138, v139, v209
  v_max3_f32 v208, v124, v125, v208
  v_max3_f32 v209, v140, v141, v209
  v_max3_f32 v208, v126, v127, v208
  v_max3_f32 v209, v142, v143, v209
  s_cmp_lt_u32 s89, 5
  s_cbranch_scc1 A_p1_last0
  s_waitcnt lgkmcnt(0)
  v_mfma_f32_32x32x16_bf16 v[112:127], v[152:155], v[8:11], 0
  v_mfma_f32_32x32x16_bf16 v[128:143], v[156:159], v[12:15], 0
  ds_read_b128 v[144:147], v4 offset:2048
  ds_read_b128 v[148:151], v4 offset:14336
  v_max3_f32 v208, v80, v81, v208
  v_max3_f32 v209, v96, v97, v209
  v_max3_f32 v208, v82, v83, v208
  v_max3_f32 v209, v98, v99, v209
  v_max3_f32 v208, v84, v85, v208
  v_max3_f32 v209, v100, v101, v209
  v_max3_f32 v208, v86, v87, v208
  v_max3_f32 v209, v102, v103, v209
  v_max3_f32 v208, v88, v89, v208
  v_max3_f32 v209, v104, v105, v209
  v_max3_f32 v208, v90, v91, v208
  v_max3_f32 v209, v106, v107, v209
  v_max3_f32 v208, v92, v93, v208
  v_max3_f32 v209, v108, v109, v209
  v_max3_f32 v208, v94, v95, v208
  v_max3_f32 v209, v110, v111, v209
  s_cmp_lt_u32 s89, 6
  s_cbranch_scc1 A_p1_last1
  s_waitcnt lgkmcnt(0)
  v_mfma_f32_32x32x16_bf16 v[80:95], v[144:147], v[8:11], 0
  v_mfma_f32_32x32x16_bf16 v[96:111], v[148:151], v[12:15], 0
  ds_read_b128 v[152:155], v4 offset:1024
  ds_read_b128 v[156:159], v4 offset:13312
  v_max3_f32 v208, v112, v113, v208
  v_max3_f32 v209, v128, v129, v209
  v_max3_f32 v208, v114, v115, v208
  v_max3_f32 v209, v130, v131, v209
  v_max3_f32 v208, v116, v117, v208
  v_max3_f32 v209, v132, v133, v209
  v_max3_f32 v208, v118, v119, v208
  v_max3_f32 v209, v134, v135, v209
  v_max3_f32 v208, v120, v121, v208
  v_max3_f32 v209, v136, v137, v209
  v_max3_f32 v208, v122, v123, v208
  v_max3_f32 v209, v138, v139, v209
  v_max3_f32 v208, v124, v125, v208
  v_max3_f32 v209, v140, v141, v209
  v_max3_f32 v208, v126, v127, v208
  v_max3_f32 v209, v142, v143, v209
  s_cmp_lt_u32 s89, 7
  s_cbranch_scc1 A_p1_last0
  s_waitcnt lgkmcnt(0)
  v_mfma_f32_32x32x16_bf16 v[112:127], v[152:155], v[8:11], 0
  v_mfma_f32_32x32x16_bf16 v[128:143], v[156:159], v[12:15], 0
  ds_read_b128 v[144:147], v4 offset:0
  ds_read_b128 v[148:151], v4 offset:12288
  v_max3_f32 v208, v80, v81, v208
  v_max3_f32 v209, v96, v97, v209
  v_max3_f32 v208, v82, v83, v208
  v_max3_f32 v209, v98, v99, v209
  v_max3_f32 v208, v84, v85, v208
  v_max3_f32 v209, v100, v101, v209
  v_max3_f32 v208, v86, v87, v208
  v_max3_f32 v209, v102, v103, v209
  v_max3_f32 v208, v88, v89, v208
  v_max3_f32 v209, v104, v105, v209
  v_max3_f32 v208, v90, v91, v208
  v_max3_f32 v209, v106, v107, v209
  v_max3_f32 v208, v92, v93, v208
  v_max3_f32 v209, v108, v109, v209
  v_max3_f32 v208, v94, v95, v208
  v_max3_f32 v209, v110, v111, v209
  s_cmp_lt_u32 s89, 8
  s_cbranch_scc1 A_p1_last1
  v_cndmask_b32 v32, 0, v6, s[32:33]
  v_cndmask_b32 v33, 0, v6, s[34:35]
  v_cndmask_b32 v34, 0, v6, s[36:37]
  v_cndmask_b32 v35, 0, v6, s[38:39]
  v_cndmask_b32 v36, 0, v6, s[40:41]
  v_cndmask_b32 v37, 0, v6, s[42:43]
  v_cndmask_b32 v38, 0, v6, s[44:45]
  v_cndmask_b32 v39, 0, v6, s[46:47]
  v_cndmask_b32 v40, 0, v6, s[48:49]
  v_cndmask_b32 v41, 0, v6, s[50:51]
  v_cndmask_b32 v42, 0, v6, s[52:53]
  v_cndmask_b32 v43, 0, v6, s[54:55]
  v_cndmask_b32 v44, 0, v6, s[56:57]
  v_cndmask_b32 v45, 0, v6, s[58:59]
  v_cndmask_b32 v46, 0, v6, s[60:61]
  v_cndmask_b32 v47, 0, v6, s[62:63]
  s_waitcnt lgkmcnt(0)
  s_nop 0
  v_mfma_f32_32x32x16_bf16 v[80:95], v[144:147], v[8:11], v[32:47]
  v_mfma_f32_32x32x16_bf16 v[96:111], v[148:151], v[12:15], v[32:47]
  v_max3_f32 v208, v112, v113, v208
  v_max3_f32 v209, v128, v129, v209
  v_max3_f32 v208, v114, v115, v208
  v_max3_f32 v209, v130, v131, v209
  v_max3_f32 v208, v116, v117, v208
  v_max3_f32 v209, v132, v133, v209
  v_max3_f32 v208, v118, v119, v208
  v_max3_f32 v209, v134, v135, v209
  v_max3_f32 v208, v120, v121, v208
  v_max3_f32 v209, v136, v137, v209
  v_max3_f32 v208, v122, v123, v208
  v_max3_f32 v209, v138, v139, v209
  v_max3_f32 v208, v124, v125, v208
  v_max3_f32 v209, v140, v141, v209
  v_max3_f32 v208, v126, v127, v208
  v_max3_f32 v209, v142, v143, v209
  s_nop 7
  s_nop 3
  s_branch A_p1_last0
A_p1_last1:
  s_nop 7
  s_nop 3
  v_max3_f32 v208, v112, v113, v208
  v_max3_f32 v209, v128, v129, v209
  v_max3_f32 v208, v114, v115, v208
  v_max3_f32 v209, v130, v131, v209
  v_max3_f32 v208, v116, v117, v208
  v_max3_f32 v209, v132, v133, v209
  v_max3_f32 v208, v118, v119, v208
  v_max3_f32 v209, v134, v135, v209
  v_max3_f32 v208, v120, v121, v208
  v_max3_f32 v209, v136, v137, v209
  v_max3_f32 v208, v122, v123, v208
  v_max3_f32 v209, v138, v139, v209
  v_max3_f32 v208, v124, v125, v208
  v_max3_f32 v209, v140, v141, v209
  v_max3_f32 v208, v126, v127, v208
  v_max3_f32 v209, v142, v143, v209
  s_branch A_p1_done
A_p1_last0:
  v_max3_f32 v208, v80, v81, v208
  v_max3_f32 v209, v96, v97, v209
  v_max3_f32 v208, v82, v83, v208
  v_max3_f32 v209, v98, v99, v209
  v_max3_f32 v208, v84, v85, v208
  v_max3_f32 v209, v100, v101, v209
  v_max3_f32 v208, v86, v87, v208
  v_max3_f32 v209, v102, v103, v209
  v_max3_f32 v208, v88, v89, v208
  v_max3_f32 v209, v104, v105, v209
  v_max3_f32 v208, v90, v91, v208
  v_max3_f32 v209, v106, v107, v209
  v_max3_f32 v208, v92, v93, v208
  v_max3_f32 v209, v108, v109, v209
  v_max3_f32 v208, v94, v95, v208
  v_max3_f32 v209, v110, v111, v209
A_p1_done:
  s_cmp_eq_u32 s10, 0
  s_cbranch_scc1 A_nohl
  s_cmp_eq_u32 s95, 1
  s_cselect_b32 exec_lo, 12, 15
  s_mov_b32 exec_hi, 0
  s_waitcnt vmcnt(0)
  v_cmp_ne_u32 vcc, s31, v214
  s_nop 3
  s_cbranch_vccz A_pollk_ok
  s_mov_b32 s93, 0
A_pollk:
  buffer_load_dword v214, v2, s[12:15], 0 offen sc1
  s_add_u32 s93, s93, 1
  s_waitcnt vmcnt(0)
  v_cmp_ne_u32 vcc, s31, v214
  s_cmp_ge_u32 s93, 100000
  s_cbranch_scc1 A_pollk_ok
  s_nop 1
  s_cbranch_vccz A_pollk_ok
  s_sleep 4
  s_branch A_pollk
A_pollk_ok:
  s_mov_b64 exec, -1
  s_lshl1_add_u32 s86, s94, s91
  s_lshl_b32 s86, s86, 17
  s_lshl_b32 s28, s9, 16
  s_add_u32 s28, s28, s86
  s_lshl_b32 s87, s95, 12
  s_add_u32 s28, s28, s87
  s_add_u32 s28, s28, 2088960
  s_mul_i32 s88, s24, 12288
  s_add_u32 m0, s88, 0
  s_nop 0
  buffer_load_dwordx4 v3, s[12:15], s28 offen offset:0 sc1 lds
  buffer_load_dwordx4 v3, s[12:15], s28 offen offset:1024 sc1 lds
  buffer_load_dwordx4 v3, s[12:15], s28 offen offset:2048 sc1 lds
  buffer_load_dwordx4 v3, s[12:15], s28 offen offset:3072 sc1 lds
  s_add_u32 m0, s88, 4096
  s_add_u32 s28, s28, 4096
  buffer_load_dwordx4 v3, s[12:15], s28 offen offset:0 sc1 lds
  buffer_load_dwordx4 v3, s[12:15], s28 offen offset:1024 sc1 lds
  buffer_load_dwordx4 v3, s[12:15], s28 offen offset:2048 sc1 lds
  buffer_load_dwordx4 v3, s[12:15], s28 offen offset:3072 sc1 lds
  s_lshl_b32 s88, s9, 13
  s_add_u32 s28, s86, s88
  s_lshl_b32 s87, s95, 13
  s_add_u32 s28, s28, s87
  s_add_u32 s28, s28, 4177920
  s_mul_i32 s87, s91, 24576
  s_add_u32 s88, s88, s87
  s_add_u32 s88, s88, 49152
  s_add_u32 m0, s88, 0
  s_nop 0
  buffer_load_dwordx4 v3, s[12:15], s28 offen offset:0 sc1 lds
  buffer_load_dwordx4 v3, s[12:15], s28 offen offset:1024 sc1 lds
  buffer_load_dwordx4 v3, s[12:15], s28 offen offset:2048 sc1 lds
  buffer_load_dwordx4 v3, s[12:15], s28 offen offset:3072 sc1 lds
  s_add_u32 m0, s88, 4096
  s_add_u32 s28, s28, 4096
  buffer_load_dwordx4 v3, s[12:15], s28 offen offset:0 sc1 lds
  buffer_load_dwordx4 v3, s[12:15], s28 offen offset:1024 sc1 lds
  buffer_load_dwordx4 v3, s[12:15], s28 offen offset:2048 sc1 lds
  buffer_load_dwordx4 v3, s[12:15], s28 offen offset:3072 sc1 lds
  s_setprio 1
A_nohl:
  s_waitcnt lgkmcnt(0)
  ds_read_b128 v[144:147], v4 offset:8192
  ds_read_b128 v[148:151], v4 offset:20480
  ds_read_b128 v[152:155], v4 offset:7168
  ds_read_b128 v[156:159], v4 offset:19456
  s_mov_b64 exec, s[4:5]
  ds_read_b128 v[176:179], v5 offset:16384
  ds_read_b128 v[180:183], v5 offset:17408
  s_mov_b64 exec, s[6:7]
  ds_read_b128 v[184:187], v5 offset:16384
  ds_read_b128 v[188:191], v5 offset:17408
  s_mov_b64 exec, -1
  v_mov_b32 v210, v208
  v_mov_b32 v211, v209
  s_nop 0
  v_permlane32_swap_b32 v208, v210
  v_permlane32_swap_b32 v209, v211
  v_max_f32 v208, v208, v210
  v_max_f32 v209, v209, v211
  v_sub_f32 v208, 0, v208
  v_sub_f32 v209, 0, v209
  v_cndmask_b32 v80, v6, v208, s[32:33]
  v_cndmask_b32 v96, v6, v209, s[32:33]
  v_cndmask_b32 v81, v6, v208, s[34:35]
  v_cndmask_b32 v97, v6, v209, s[34:35]
  v_cndmask_b32 v82, v6, v208, s[36:37]
  v_cndmask_b32 v98, v6, v209, s[36:37]
  v_cndmask_b32 v83, v6, v208, s[38:39]
  v_cndmask_b32 v99, v6, v209, s[38:39]
  v_cndmask_b32 v84, v6, v208, s[40:41]
  v_cndmask_b32 v100, v6, v209, s[40:41]
  v_cndmask_b32 v85, v6, v208, s[42:43]
  v_cndmask_b32 v101, v6, v209, s[42:43]
  v_cndmask_b32 v86, v6, v208, s[44:45]
  v_cndmask_b32 v102, v6, v209, s[44:45]
  v_cndmask_b32 v87, v6, v208, s[46:47]
  v_cndmask_b32 v103, v6, v209, s[46:47]
  v_cndmask_b32 v88, v6, v208, s[48:49]
  v_cndmask_b32 v104, v6, v209, s[48:49]
  v_cndmask_b32 v89, v6, v208, s[50:51]
  v_cndmask_b32 v105, v6, v209, s[50:51]
  v_cndmask_b32 v90, v6, v208, s[52:53]
  v_cndmask_b32 v106, v6, v209, s[52:53]
  v_cndmask_b32 v91, v6, v208, s[54:55]
  v_cndmask_b32 v107, v6, v209, s[54:55]
  v_cndmask_b32 v92, v6, v208, s[56:57]
  v_cndmask_b32 v108, v6, v209, s[56:57]
  v_cndmask_b32 v93, v6, v208, s[58:59]
  v_cndmask_b32 v109, v6, v209, s[58:59]
  v_cndmask_b32 v94, v6, v208, s[60:61]
  v_cndmask_b32 v110, v6, v209, s[60:61]
  v_cndmask_b32 v95, v6, v208, s[62:63]
  v_cndmask_b32 v111, v6, v209, s[62:63]
  s_waitcnt lgkmcnt(0)
  v_mfma_f32_32x32x16_bf16 v[80:95], v[144:147], v[8:11], v[80:95]
  v_mfma_f32_32x32x16_bf16 v[96:111], v[148:151], v[12:15], v[96:111]
  v_mov_b32 v16, v208
  v_mov_b32 v32, v209
  v_mov_b32 v17, v208
  v_mov_b32 v33, v209
  v_mov_b32 v18, v208
  v_mov_b32 v34, v209
  v_mov_b32 v19, v208
  v_mov_b32 v35, v209
  v_mov_b32 v20, v208
  v_mov_b32 v36, v209
  v_mov_b32 v21, v208
  v_mov_b32 v37, v209
  v_mov_b32 v22, v208
  v_mov_b32 v38, v209
  v_mov_b32 v23, v208
  v_mov_b32 v39, v209
  v_mov_b32 v24, v208
  v_mov_b32 v40, v209
  v_mov_b32 v25, v208
  v_mov_b32 v41, v209
  v_mov_b32 v26, v208
  v_mov_b32 v42, v209
  v_mov_b32 v27, v208
  v_mov_b32 v43, v209
  v_mov_b32 v28, v208
  v_mov_b32 v44, v209
  v_mov_b32 v29, v208
  v_mov_b32 v45, v209
  v_mov_b32 v30, v208
  v_mov_b32 v46, v209
  v_mov_b32 v31, v208
  v_mov_b32 v47, v209
  s_cmp_lt_u32 s90, 1
  s_cbranch_scc1 A_p2_last0
  s_cmp_eq_u32 s8, 0
  s_cbranch_scc1 A_p2_hw0
  s_waitcnt lgkmcnt(0)
  v_mfma_f32_32x32x16_bf16 v[112:127], v[152:155], v[8:11], v[16:31]
  v_mfma_f32_32x32x16_bf16 v[128:143], v[156:159], v[12:15], v[32:47]
  ds_read_b128 v[144:147], v4 offset:6144
  ds_read_b128 v[148:151], v4 offset:18432
  s_mov_b64 exec, s[4:5]
  ds_read_b128 v[192:195], v5 offset:14336
  ds_read_b128 v[196:199], v5 offset:15360
  s_mov_b64 exec, s[6:7]
  ds_read_b128 v[200:203], v5 offset:14336
  ds_read_b128 v[204:207], v5 offset:15360
  s_mov_b64 exec, -1
  v_exp_f32 v80, v80
  v_exp_f32 v81, v81
  v_exp_f32 v82, v82
  v_exp_f32 v83, v83
  v_exp_f32 v84, v84
  v_exp_f32 v85, v85
  v_exp_f32 v86, v86
  v_exp_f32 v87, v87
  v_cvt_pk_bf16_f32 v160, v80, v81
  v_cvt_pk_bf16_f32 v161, v82, v83
  v_cvt_pk_bf16_f32 v162, v84, v85
  v_cvt_pk_bf16_f32 v163, v86, v87
  v_exp_f32 v88, v88
  v_exp_f32 v89, v89
  v_mfma_f32_32x32x16_bf16 v[48:63], v[176:179], v[160:163], v[48:63]
  v_exp_f32 v90, v90
  v_exp_f32 v91, v91
  v_exp_f32 v92, v92
  v_exp_f32 v93, v93
  v_exp_f32 v94, v94
  v_exp_f32 v95, v95
  v_cvt_pk_bf16_f32 v164, v88, v89
  v_cvt_pk_bf16_f32 v165, v90, v91
  v_cvt_pk_bf16_f32 v166, v92, v93
  v_cvt_pk_bf16_f32 v167, v94, v95
  v_exp_f32 v96, v96
  v_exp_f32 v97, v97
  v_mfma_f32_32x32x16_bf16 v[48:63], v[180:183], v[164:167], v[48:63]
  v_exp_f32 v98, v98
  v_exp_f32 v99, v99
  v_exp_f32 v100, v100
  v_exp_f32 v101, v101
  v_exp_f32 v102, v102
  v_exp_f32 v103, v103
  v_cvt_pk_bf16_f32 v168, v96, v97
  v_cvt_pk_bf16_f32 v169, v98, v99
  v_cvt_pk_bf16_f32 v170, v100, v101
  v_cvt_pk_bf16_f32 v171, v102, v103
  v_exp_f32 v104, v104
  v_exp_f32 v105, v105
  v_mfma_f32_32x32x16_bf16 v[64:79], v[184:187], v[168:171], v[64:79]
  v_exp_f32 v106, v106
  v_exp_f32 v107, v107
  v_exp_f32 v108, v108
  v_exp_f32 v109, v109
  v_exp_f32 v110, v110
  v_exp_f32 v111, v111
  v_cvt_pk_bf16_f32 v172, v104, v105
  v_cvt_pk_bf16_f32 v173, v106, v107
  v_cvt_pk_bf16_f32 v174, v108, v109
  v_cvt_pk_bf16_f32 v175, v110, v111
  s_nop 1
  v_mfma_f32_32x32x16_bf16 v[64:79], v[188:191], v[172:175], v[64:79]
A_p2_it1:
  s_cmp_lt_u32 s90, 2
  s_cbranch_scc1 A_p2_last1
  s_cmp_eq_u32 s8, 1
  s_cbranch_scc1 A_p2_hw1
  s_waitcnt lgkmcnt(0)
  v_mfma_f32_32x32x16_bf16 v[80:95], v[144:147], v[8:11], v[16:31]
  v_mfma_f32_32x32x16_bf16 v[96:111], v[148:151], v[12:15], v[32:47]
  ds_read_b128 v[152:155], v4 offset:5120
  ds_read_b128 v[156:159], v4 offset:17408
  s_mov_b64 exec, s[4:5]
  ds_read_b128 v[176:179], v5 offset:12288
  ds_read_b128 v[180:183], v5 offset:13312
  s_mov_b64 exec, s[6:7]
  ds_read_b128 v[184:187], v5 offset:12288
  ds_read_b128 v[188:191], v5 offset:13312
  s_mov_b64 exec, -1
  v_exp_f32 v112, v112
  v_exp_f32 v113, v113
  v_exp_f32 v114, v114
  v_exp_f32 v115, v115
  v_exp_f32 v116, v116
  v_exp_f32 v117, v117
  v_exp_f32 v118, v118
  v_exp_f32 v119, v119
  v_cvt_pk_bf16_f32 v160, v112, v113
  v_cvt_pk_bf16_f32 v161, v114, v115
  v_cvt_pk_bf16_f32 v162, v116, v117
  v_cvt_pk_bf16_f32 v163, v118, v119
  v_exp_f32 v120, v120
  v_exp_f32 v121, v121
  v_mfma_f32_32x32x16_bf16 v[48:63], v[192:195], v[160:163], v[48:63]
  v_exp_f32 v122, v122
  v_exp_f32 v123, v123
  v_exp_f32 v124, v124
  v_exp_f32 v125, v125
  v_exp_f32 v126, v126
  v_exp_f32 v127, v127
  v_cvt_pk_bf16_f32 v164, v120, v121
  v_cvt_pk_bf16_f32 v165, v122, v123
  v_cvt_pk_bf16_f32 v166, v124, v125
  v_cvt_pk_bf16_f32 v167, v126, v127
  v_exp_f32 v128, v128
  v_exp_f32 v129, v129
  v_mfma_f32_32x32x16_bf16 v[48:63], v[196:199], v[164:167], v[48:63]
  v_exp_f32 v130, v130
  v_exp_f32 v131, v131
  v_exp_f32 v132, v132
  v_exp_f32 v133, v133
  v_exp_f32 v134, v134
  v_exp_f32 v135, v135
  v_cvt_pk_bf16_f32 v168, v128, v129
  v_cvt_pk_bf16_f32 v169, v130, v131
  v_cvt_pk_bf16_f32 v170, v132, v133
  v_cvt_pk_bf16_f32 v171, v134, v135
  v_exp_f32 v136, v136
  v_exp_f32 v137, v137
  v_mfma_f32_32x32x16_bf16 v[64:79], v[200:203], v[168:171], v[64:79]
  v_exp_f32 v138, v138
  v_exp_f32 v139, v139
  v_exp_f32 v140, v140
  v_exp_f32 v141, v141
  v_exp_f32 v142, v142
  v_exp_f32 v143, v143
  v_cvt_pk_bf16_f32 v172, v136, v137
  v_cvt_pk_bf16_f32 v173, v138, v139
  v_cvt_pk_bf16_f32 v174, v140, v141
  v_cvt_pk_bf16_f32 v175, v142, v143
  s_nop 1
  v_mfma_f32_32x32x16_bf16 v[64:79], v[204:207], v[172:175], v[64:79]
A_p2_it2:
  s_cmp_lt_u32 s90, 3
  s_cbranch_scc1 A_p2_last0
  s_cmp_eq_u32 s8, 2
  s_cbranch_scc1 A_p2_hw2
  s_waitcnt lgkmcnt(0)
  v_mfma_f32_32x32x16_bf16 v[112:127], v[152:155], v[8:11], v[16:31]
  v_mfma_f32_32x32x16_bf16 v[128:143], v[156:159], v[12:15], v[32:47]
  ds_read_b128 v[144:147], v4 offset:4096
  ds_read_b128 v[148:151], v4 offset:16384
  s_mov_b64 exec, s[4:5]
  ds_read_b128 v[192:195], v5 offset:10240
  ds_read_b128 v[196:199], v5 offset:11264
  s_mov_b64 exec, s[6:7]
  ds_read_b128 v[200:203], v5 offset:10240
  ds_read_b128 v[204:207], v5 offset:11264
  s_mov_b64 exec, -1
  v_exp_f32 v80, v80
  v_exp_f32 v81, v81
  v_exp_f32 v82, v82
  v_exp_f32 v83, v83
  v_exp_f32 v84, v84
  v_exp_f32 v85, v85
  v_exp_f32 v86, v86
  v_exp_f32 v87, v87
  v_cvt_pk_bf16_f32 v160, v80, v81
  v_cvt_pk_bf16_f32 v161, v82, v83
  v_cvt_pk_bf16_f32 v162, v84, v85
  v_cvt_pk_bf16_f32 v163, v86, v87
  v_exp_f32 v88, v88
  v_exp_f32 v89, v89
  v_mfma_f32_32x32x16_bf16 v[48:63], v[176:179], v[160:163], v[48:63]
  v_exp_f32 v90, v90
  v_exp_f32 v91, v91
  v_exp_f32 v92, v92
  v_exp_f32 v93, v93
  v_exp_f32 v94, v94
  v_exp_f32 v95, v95
  v_cvt_pk_bf16_f32 v164, v88, v89
  v_cvt_pk_bf16_f32 v165, v90, v91
  v_cvt_pk_bf16_f32 v166, v92, v93
  v_cvt_pk_bf16_f32 v167, v94, v95
  v_exp_f32 v96, v96
  v_exp_f32 v97, v97
  v_mfma_f32_32x32x16_bf16 v[48:63], v[180:183], v[164:167], v[48:63]
  v_exp_f32 v98, v98
  v_exp_f32 v99, v99
  v_exp_f32 v100, v100
  v_exp_f32 v101, v101
  v_exp_f32 v102, v102
  v_exp_f32 v103, v103
  v_cvt_pk_bf16_f32 v168, v96, v97
  v_cvt_pk_bf16_f32 v169, v98, v99
  v_cvt_pk_bf16_f32 v170, v100, v101
  v_cvt_pk_bf16_f32 v171, v102, v103
  v_exp_f32 v104, v104
  v_exp_f32 v105, v105
  v_mfma_f32_32x32x16_bf16 v[64:79], v[184:187], v[168:171], v[64:79]
  v_exp_f32 v106, v106
  v_exp_f32 v107, v107
  v_exp_f32 v108, v108
  v_exp_f32 v109, v109
  v_exp_f32 v110, v110
  v_exp_f32 v111, v111
  v_cvt_pk_bf16_f32 v172, v104, v105
  v_cvt_pk_bf16_f32 v173, v106, v107
  v_cvt_pk_bf16_f32 v174, v108, v109
  v_cvt_pk_bf16_f32 v175, v110, v111
  s_nop 1
  v_mfma_f32_32x32x16_bf16 v[64:79], v[188:191], v[172:175], v[64:79]
A_p2_it3:
  s_cmp_lt_u32 s90, 4
  s_cbranch_scc1 A_p2_last1
  s_cmp_eq_u32 s8, 3
  s_cbranch_scc1 A_p2_hw3
  s_waitcnt lgkmcnt(0)
  v_mfma_f32_32x32x16_bf16 v[80:95], v[144:147], v[8:11], v[16:31]
  v_mfma_f32_32x32x16_bf16 v[96:111], v[148:151], v[12:15], v[32:47]
  ds_read_b128 v[152:155], v4 offset:3072
  ds_read_b128 v[156:159], v4 offset:15360
  s_mov_b64 exec, s[4:5]
  ds_read_b128 v[176:179], v5 offset:8192
  ds_read_b128 v[180:183], v5 offset:9216
  s_mov_b64 exec, s[6:7]
  ds_read_b128 v[184:187], v5 offset:8192
  ds_read_b128 v[188:191], v5 offset:9216
  s_mov_b64 exec, -1
  v_exp_f32 v112, v112
  v_exp_f32 v113, v113
  v_exp_f32 v114, v114
  v_exp_f32 v115, v115
  v_exp_f32 v116, v116
  v_exp_f32 v117, v117
  v_exp_f32 v118, v118
  v_exp_f32 v119, v119
  v_cvt_pk_bf16_f32 v160, v112, v113
  v_cvt_pk_bf16_f32 v161, v114, v115
  v_cvt_pk_bf16_f32 v162, v116, v117
  v_cvt_pk_bf16_f32 v163, v118, v119
  v_exp_f32 v120, v120
  v_exp_f32 v121, v121
  v_mfma_f32_32x32x16_bf16 v[48:63], v[192:195], v[160:163], v[48:63]
  v_exp_f32 v122, v122
  v_exp_f32 v123, v123
  v_exp_f32 v124, v124
  v_exp_f32 v125, v125
  v_exp_f32 v126, v126
  v_exp_f32 v127, v127
  v_cvt_pk_bf16_f32 v164, v120, v121
  v_cvt_pk_bf16_f32 v165, v122, v123
  v_cvt_pk_bf16_f32 v166, v124, v125
  v_cvt_pk_bf16_f32 v167, v126, v127
  v_exp_f32 v128, v128
  v_exp_f32 v129, v129
  v_mfma_f32_32x32x16_bf16 v[48:63], v[196:199], v[164:167], v[48:63]
  v_exp_f32 v130, v130
  v_exp_f32 v131, v131
  v_exp_f32 v132, v132
  v_exp_f32 v133, v133
  v_exp_f32 v134, v134
  v_exp_f32 v135, v135
  v_cvt_pk_bf16_f32 v168, v128, v129
  v_cvt_pk_bf16_f32 v169, v130, v131
  v_cvt_pk_bf16_f32 v170, v132, v133
  v_cvt_pk_bf16_f32 v171, v134, v135
  v_exp_f32 v136, v136
  v_exp_f32 v137, v137
  v_mfma_f32_32x32x16_bf16 v[64:79], v[200:203], v[168:171], v[64:79]
  v_exp_f32 v138, v138
  v_exp_f32 v139, v139
  v_exp_f32 v140, v140
  v_exp_f32 v141, v141
  v_exp_f32 v142, v142
  v_exp_f32 v143, v143
  v_cvt_pk_bf16_f32 v172, v136, v137
  v_cvt_pk_bf16_f32 v173, v138, v139
  v_cvt_pk_bf16_f32 v174, v140, v141
  v_cvt_pk_bf16_f32 v175, v142, v143
  s_nop 1
  v_mfma_f32_32x32x16_bf16 v[64:79], v[204:207], v[172:175], v[64:79]
A_p2_it4:
  s_cmp_lt_u32 s90, 5
  s_cbranch_scc1 A_p2_last0
  s_waitcnt lgkmcnt(0)
  v_mfma_f32_32x32x16_bf16 v[112:127], v[152:155], v[8:11], v[16:31]
  v_mfma_f32_32x32x16_bf16 v[128:143], v[156:159], v[12:15], v[32:47]
  ds_read_b128 v[144:147], v4 offset:2048
  ds_read_b128 v[148:151], v4 offset:14336
  s_mov_b64 exec, s[4:5]
  ds_read_b128 v[192:195], v5 offset:6144
  ds_read_b128 v[196:199], v5 offset:7168
  s_mov_b64 exec, s[6:7]
  ds_read_b128 v[200:203], v5 offset:6144
  ds_read_b128 v[204:207], v5 offset:7168
  s_mov_b64 exec, -1
  buffer_load_dword v251, v248, s[16:19], 0 offen
  v_exp_f32 v80, v80
  v_exp_f32 v81, v81
  v_exp_f32 v82, v82
  v_exp_f32 v83, v83
  v_exp_f32 v84, v84
  v_exp_f32 v85, v85
  v_exp_f32 v86, v86
  v_exp_f32 v87, v87
  v_cvt_pk_bf16_f32 v160, v80, v81
  v_cvt_pk_bf16_f32 v161, v82, v83
  v_cvt_pk_bf16_f32 v162, v84, v85
  v_cvt_pk_bf16_f32 v163, v86, v87
  v_exp_f32 v88, v88
  v_exp_f32 v89, v89
  v_mfma_f32_32x32x16_bf16 v[48:63], v[176:179], v[160:163], v[48:63]
  v_exp_f32 v90, v90
  v_exp_f32 v91, v91
  v_exp_f32 v92, v92
  v_exp_f32 v93, v93
  v_exp_f32 v94, v94
  v_exp_f32 v95, v95
  v_cvt_pk_bf16_f32 v164, v88, v89
  v_cvt_pk_bf16_f32 v165, v90, v91
  v_cvt_pk_bf16_f32 v166, v92, v93
  v_cvt_pk_bf16_f32 v167, v94, v95
  v_exp_f32 v96, v96
  v_exp_f32 v97, v97
  v_mfma_f32_32x32x16_bf16 v[48:63], v[180:183], v[164:167], v[48:63]
  v_exp_f32 v98, v98
  v_exp_f32 v99, v99
  v_exp_f32 v100, v100
  v_exp_f32 v101, v101
  v_exp_f32 v102, v102
  v_exp_f32 v103, v103
  v_cvt_pk_bf16_f32 v168, v96, v97
  v_cvt_pk_bf16_f32 v169, v98, v99
  v_cvt_pk_bf16_f32 v170, v100, v101
  v_cvt_pk_bf16_f32 v171, v102, v103
  v_exp_f32 v104, v104
  v_exp_f32 v105, v105
  v_mfma_f32_32x32x16_bf16 v[64:79], v[184:187], v[168:171], v[64:79]
  v_exp_f32 v106, v106
  v_exp_f32 v107, v107
  v_exp_f32 v108, v108
  v_exp_f32 v109, v109
  v_exp_f32 v110, v110
  v_exp_f32 v111, v111
  v_cvt_pk_bf16_f32 v172, v104, v105
  v_cvt_pk_bf16_f32 v173, v106, v107
  v_cvt_pk_bf16_f32 v174, v108, v109
  v_cvt_pk_bf16_f32 v175, v110, v111
  s_nop 1
  v_mfma_f32_32x32x16_bf16 v[64:79], v[188:191], v[172:175], v[64:79]
  s_cmp_lt_u32 s90, 6
  s_cbranch_scc1 A_p2_last1
  s_waitcnt lgkmcnt(0)
  v_mfma_f32_32x32x16_bf16 v[80:95], v[144:147], v[8:11], v[16:31]
  v_mfma_f32_32x32x16_bf16 v[96:111], v[148:151], v[12:15], v[32:47]
  ds_read_b128 v[152:155], v4 offset:1024
  ds_read_b128 v[156:159], v4 offset:13312
  s_mov_b64 exec, s[4:5]
  ds_read_b128 v[176:179], v5 offset:4096
  ds_read_b128 v[180:183], v5 offset:5120
  s_mov_b64 exec, s[6:7]
  ds_read_b128 v[184:187], v5 offset:4096
  ds_read_b128 v[188:191], v5 offset:5120
  s_mov_b64 exec, -1
  buffer_load_dword v251, v249, s[16:19], 0 offen
  buffer_load_dword v251, v250, s[20:23], 0 offen
  v_exp_f32 v112, v112
  v_exp_f32 v113, v113
  v_exp_f32 v114, v114
  v_exp_f32 v115, v115
  v_exp_f32 v116, v116
  v_exp_f32 v117, v117
  v_exp_f32 v118, v118
  v_exp_f32 v119, v119
  v_cvt_pk_bf16_f32 v160, v112, v113
  v_cvt_pk_bf16_f32 v161, v114, v115
  v_cvt_pk_bf16_f32 v162, v116, v117
  v_cvt_pk_bf16_f32 v163, v118, v119
  v_exp_f32 v120, v120
  v_exp_f32 v121, v121
  v_mfma_f32_32x32x16_bf16 v[48:63], v[192:195], v[160:163], v[48:63]
  v_exp_f32 v122, v122
  v_exp_f32 v123, v123
  v_exp_f32 v124, v124
  v_exp_f32 v125, v125
  v_exp_f32 v126, v126
  v_exp_f32 v127, v127
  v_cvt_pk_bf16_f32 v164, v120, v121
  v_cvt_pk_bf16_f32 v165, v122, v123
  v_cvt_pk_bf16_f32 v166, v124, v125
  v_cvt_pk_bf16_f32 v167, v126, v127
  v_exp_f32 v128, v128
  v_exp_f32 v129, v129
  v_mfma_f32_32x32x16_bf16 v[48:63], v[196:199], v[164:167], v[48:63]
  v_exp_f32 v130, v130
  v_exp_f32 v131, v131
  v_exp_f32 v132, v132
  v_exp_f32 v133, v133
  v_exp_f32 v134, v134
  v_exp_f32 v135, v135
  v_cvt_pk_bf16_f32 v168, v128, v129
  v_cvt_pk_bf16_f32 v169, v130, v131
  v_cvt_pk_bf16_f32 v170, v132, v133
  v_cvt_pk_bf16_f32 v171, v134, v135
  v_exp_f32 v136, v136
  v_exp_f32 v137, v137
  v_mfma_f32_32x32x16_bf16 v[64:79], v[200:203], v[168:171], v[64:79]
  v_exp_f32 v138, v138
  v_exp_f32 v139, v139
  v_exp_f32 v140, v140
  v_exp_f32 v141, v141
  v_exp_f32 v142, v142
  v_exp_f32 v143, v143
  v_cvt_pk_bf16_f32 v172, v136, v137
  v_cvt_pk_bf16_f32 v173, v138, v139
  v_cvt_pk_bf16_f32 v174, v140, v141
  v_cvt_pk_bf16_f32 v175, v142, v143
  s_nop 1
  v_mfma_f32_32x32x16_bf16 v[64:79], v[204:207], v[172:175], v[64:79]
  s_cmp_lt_u32 s90, 7
  s_cbranch_scc1 A_p2_last0
  s_waitcnt lgkmcnt(0)
  v_mfma_f32_32x32x16_bf16 v[112:127], v[152:155], v[8:11], v[16:31]
  v_mfma_f32_32x32x16_bf16 v[128:143], v[156:159], v[12:15], v[32:47]
  ds_read_b128 v[144:147], v4 offset:0
  ds_read_b128 v[148:151], v4 offset:12288
  s_mov_b64 exec, s[4:5]
  ds_read_b128 v[192:195], v5 offset:2048
  ds_read_b128 v[196:199], v5 offset:3072
  s_mov_b64 exec, s[6:7]
  ds_read_b128 v[200:203], v5 offset:2048
  ds_read_b128 v[204:207], v5 offset:3072
  s_mov_b64 exec, -1
  s_setprio 0
  v_exp_f32 v80, v80
  v_exp_f32 v81, v81
  v_exp_f32 v82, v82
  v_exp_f32 v83, v83
  v_exp_f32 v84, v84
  v_exp_f32 v85, v85
  v_exp_f32 v86, v86
  v_exp_f32 v87, v87
  v_cvt_pk_bf16_f32 v160, v80, v81
  v_cvt_pk_bf16_f32 v161, v82, v83
  v_cvt_pk_bf16_f32 v162, v84, v85
  v_cvt_pk_bf16_f32 v163, v86, v87
  v_exp_f32 v88, v88
  v_exp_f32 v89, v89
  v_mfma_f32_32x32x16_bf16 v[48:63], v[176:179], v[160:163], v[48:63]
  v_exp_f32 v90, v90
  v_exp_f32 v91, v91
  v_exp_f32 v92, v92
  v_exp_f32 v93, v93
  v_exp_f32 v94, v94
  v_exp_f32 v95, v95
  v_cvt_pk_bf16_f32 v164, v88, v89
  v_cvt_pk_bf16_f32 v165, v90, v91
  v_cvt_pk_bf16_f32 v166, v92, v93
  v_cvt_pk_bf16_f32 v167, v94, v95
  v_exp_f32 v96, v96
  v_exp_f32 v97, v97
  v_mfma_f32_32x32x16_bf16 v[48:63], v[180:183], v[164:167], v[48:63]
  v_exp_f32 v98, v98
  v_exp_f32 v99, v99
  v_exp_f32 v100, v100
  v_exp_f32 v101, v101
  v_exp_f32 v102, v102
  v_exp_f32 v103, v103
  v_cvt_pk_bf16_f32 v168, v96, v97
  v_cvt_pk_bf16_f32 v169, v98, v99
  v_cvt_pk_bf16_f32 v170, v100, v101
  v_cvt_pk_bf16_f32 v171, v102, v103
  v_exp_f32 v104, v104
  v_exp_f32 v105, v105
  v_mfma_f32_32x32x16_bf16 v[64:79], v[184:187], v[168:171], v[64:79]
  v_exp_f32 v106, v106
  v_exp_f32 v107, v107
  v_exp_f32 v108, v108
  v_exp_f32 v109, v109
  v_exp_f32 v110, v110
  v_exp_f32 v111, v111
  v_cvt_pk_bf16_f32 v172, v104, v105
  v_cvt_pk_bf16_f32 v173, v106, v107
  v_cvt_pk_bf16_f32 v174, v108, v109
  v_cvt_pk_bf16_f32 v175, v110, v111
  s_nop 1
  v_mfma_f32_32x32x16_bf16 v[64:79], v[188:191], v[172:175], v[64:79]
  s_cmp_lt_u32 s90, 8
  s_cbranch_scc1 A_p2_last1
  v_cndmask_b32 v16, v208, v6, s[32:33]
  v_cndmask_b32 v32, v209, v6, s[32:33]
  v_cndmask_b32 v17, v208, v6, s[34:35]
  v_cndmask_b32 v33, v209, v6, s[34:35]
  v_cndmask_b32 v18, v208, v6, s[36:37]
  v_cndmask_b32 v34, v209, v6, s[36:37]
  v_cndmask_b32 v19, v208, v6, s[38:39]
  v_cndmask_b32 v35, v209, v6, s[38:39]
  v_cndmask_b32 v20, v208, v6, s[40:41]
  v_cndmask_b32 v36, v209, v6, s[40:41]
  v_cndmask_b32 v21, v208, v6, s[42:43]
  v_cndmask_b32 v37, v209, v6, s[42:43]
  v_cndmask_b32 v22, v208, v6, s[44:45]
  v_cndmask_b32 v38, v209, v6, s[44:45]
  v_cndmask_b32 v23, v208, v6, s[46:47]
  v_cndmask_b32 v39, v209, v6, s[46:47]
  v_cndmask_b32 v24, v208, v6, s[48:49]
  v_cndmask_b32 v40, v209, v6, s[48:49]
  v_cndmask_b32 v25, v208, v6, s[50:51]
  v_cndmask_b32 v41, v209, v6, s[50:51]
  v_cndmask_b32 v26, v208, v6, s[52:53]
  v_cndmask_b32 v42, v209, v6, s[52:53]
  v_cndmask_b32 v27, v208, v6, s[54:55]
  v_cndmask_b32 v43, v209, v6, s[54:55]
  v_cndmask_b32 v28, v208, v6, s[56:57]
  v_cndmask_b32 v44, v209, v6, s[56:57]
  v_cndmask_b32 v29, v208, v6, s[58:59]
  v_cndmask_b32 v45, v209, v6, s[58:59]
  v_cndmask_b32 v30, v208, v6, s[60:61]
  v_cndmask_b32 v46, v209, v6, s[60:61]
  v_cndmask_b32 v31, v208, v6, s[62:63]
  v_cndmask_b32 v47, v209, v6, s[62:63]
  s_waitcnt lgkmcnt(0)
  v_mfma_f32_32x32x16_bf16 v[80:95], v[144:147], v[8:11], v[16:31]
  v_mfma_f32_32x32x16_bf16 v[96:111], v[148:151], v[12:15], v[32:47]
  s_mov_b64 exec, s[4:5]
  ds_read_b128 v[176:179], v5 offset:0
  ds_read_b128 v[180:183], v5 offset:1024
  s_mov_b64 exec, s[6:7]
  ds_read_b128 v[184:187], v5 offset:0
  ds_read_b128 v[188:191], v5 offset:1024
  s_mov_b64 exec, -1
  v_exp_f32 v112, v112
  v_exp_f32 v113, v113
  v_exp_f32 v114, v114
  v_exp_f32 v115, v115
  v_exp_f32 v116, v116
  v_exp_f32 v117, v117
  v_exp_f32 v118, v118
  v_exp_f32 v119, v119
  v_cvt_pk_bf16_f32 v160, v112, v113
  v_cvt_pk_bf16_f32 v161, v114, v115
  v_cvt_pk_bf16_f32 v162, v116, v117
  v_cvt_pk_bf16_f32 v163, v118, v119
  v_exp_f32 v120, v120
  v_exp_f32 v121, v121
  v_mfma_f32_32x32x16_bf16 v[48:63], v[192:195], v[160:163], v[48:63]
  v_exp_f32 v122, v122
  v_exp_f32 v123, v123
  v_exp_f32 v124, v124
  v_exp_f32 v125, v125
  v_exp_f32 v126, v126
  v_exp_f32 v127, v127
  v_cvt_pk_bf16_f32 v164, v120, v121
  v_cvt_pk_bf16_f32 v165, v122, v123
  v_cvt_pk_bf16_f32 v166, v124, v125
  v_cvt_pk_bf16_f32 v167, v126, v127
  v_exp_f32 v128, v128
  v_exp_f32 v129, v129
  v_mfma_f32_32x32x16_bf16 v[48:63], v[196:199], v[164:167], v[48:63]
  v_exp_f32 v130, v130
  v_exp_f32 v131, v131
  v_exp_f32 v132, v132
  v_exp_f32 v133, v133
  v_exp_f32 v134, v134
  v_exp_f32 v135, v135
  v_cvt_pk_bf16_f32 v168, v128, v129
  v_cvt_pk_bf16_f32 v169, v130, v131
  v_cvt_pk_bf16_f32 v170, v132, v133
  v_cvt_pk_bf16_f32 v171, v134, v135
  v_exp_f32 v136, v136
  v_exp_f32 v137, v137
  v_mfma_f32_32x32x16_bf16 v[64:79], v[200:203], v[168:171], v[64:79]
  v_exp_f32 v138, v138
  v_exp_f32 v139, v139
  v_exp_f32 v140, v140
  v_exp_f32 v141, v141
  v_exp_f32 v142, v142
  v_exp_f32 v143, v143
  v_cvt_pk_bf16_f32 v172, v136, v137
  v_cvt_pk_bf16_f32 v173, v138, v139
  v_cvt_pk_bf16_f32 v174, v140, v141
  v_cvt_pk_bf16_f32 v175, v142, v143
  s_nop 1
  v_mfma_f32_32x32x16_bf16 v[64:79], v[204:207], v[172:175], v[64:79]
A_p2_last0:
  s_waitcnt lgkmcnt(0)
  s_nop 7
  s_nop 3
  v_exp_f32 v80, v80
  v_exp_f32 v81, v81
  v_exp_f32 v82, v82
  v_exp_f32 v83, v83
  v_exp_f32 v84, v84
  v_exp_f32 v85, v85
  v_exp_f32 v86, v86
  v_exp_f32 v87, v87
  v_cvt_pk_bf16_f32 v160, v80, v81
  v_cvt_pk_bf16_f32 v161, v82, v83
  v_cvt_pk_bf16_f32 v162, v84, v85
  v_cvt_pk_bf16_f32 v163, v86, v87
  v_exp_f32 v88, v88
  v_exp_f32 v89, v89
  v_mfma_f32_32x32x16_bf16 v[48:63], v[176:179], v[160:163], v[48:63]
  v_exp_f32 v90, v90
  v_exp_f32 v91, v91
  v_exp_f32 v92, v92
  v_exp_f32 v93, v93
  v_exp_f32 v94, v94
  v_exp_f32 v95, v95
  v_cvt_pk_bf16_f32 v164, v88, v89
  v_cvt_pk_bf16_f32 v165, v90, v91
  v_cvt_pk_bf16_f32 v166, v92, v93
  v_cvt_pk_bf16_f32 v167, v94, v95
  v_exp_f32 v96, v96
  v_exp_f32 v97, v97
  v_mfma_f32_32x32x16_bf16 v[48:63], v[180:183], v[164:167], v[48:63]
  v_exp_f32 v98, v98
  v_exp_f32 v99, v99
  v_exp_f32 v100, v100
  v_exp_f32 v101, v101
  v_exp_f32 v102, v102
  v_exp_f32 v103, v103
  v_cvt_pk_bf16_f32 v168, v96, v97
  v_cvt_pk_bf16_f32 v169, v98, v99
  v_cvt_pk_bf16_f32 v170, v100, v101
  v_cvt_pk_bf16_f32 v171, v102, v103
  v_exp_f32 v104, v104
  v_exp_f32 v105, v105
  v_mfma_f32_32x32x16_bf16 v[64:79], v[184:187], v[168:171], v[64:79]
  v_exp_f32 v106, v106
  v_exp_f32 v107, v107
  v_exp_f32 v108, v108
  v_exp_f32 v109, v109
  v_exp_f32 v110, v110
  v_exp_f32 v111, v111
  v_cvt_pk_bf16_f32 v172, v104, v105
  v_cvt_pk_bf16_f32 v173, v106, v107
  v_cvt_pk_bf16_f32 v174, v108, v109
  v_cvt_pk_bf16_f32 v175, v110, v111
  s_nop 1
  v_mfma_f32_32x32x16_bf16 v[64:79], v[188:191], v[172:175], v[64:79]
  s_branch A_p2_done
A_p2_hw0:
  s_waitcnt lgkmcnt(0)
  v_exp_f32 v80, v80
  v_exp_f32 v81, v81
  v_exp_f32 v82, v82
  v_exp_f32 v83, v83
  v_exp_f32 v84, v84
  v_exp_f32 v85, v85
  v_exp_f32 v86, v86
  v_exp_f32 v87, v87
  v_cvt_pk_bf16_f32 v160, v80, v81
  v_cvt_pk_bf16_f32 v161, v82, v83
  v_cvt_pk_bf16_f32 v162, v84, v85
  v_cvt_pk_bf16_f32 v163, v86, v87
  v_exp_f32 v88, v88
  v_exp_f32 v89, v89
  v_mfma_f32_32x32x16_bf16 v[48:63], v[176:179], v[160:163], v[48:63]
  v_exp_f32 v90, v90
  v_exp_f32 v91, v91
  v_exp_f32 v92, v92
  v_exp_f32 v93, v93
  v_exp_f32 v94, v94
  v_exp_f32 v95, v95
  v_cvt_pk_bf16_f32 v164, v88, v89
  v_cvt_pk_bf16_f32 v165, v90, v91
  v_cvt_pk_bf16_f32 v166, v92, v93
  v_cvt_pk_bf16_f32 v167, v94, v95
  v_exp_f32 v96, v96
  v_exp_f32 v97, v97
  v_mfma_f32_32x32x16_bf16 v[48:63], v[180:183], v[164:167], v[48:63]
  v_exp_f32 v98, v98
  v_exp_f32 v99, v99
  v_exp_f32 v100, v100
  v_exp_f32 v101, v101
  v_exp_f32 v102, v102
  v_exp_f32 v103, v103
  v_cvt_pk_bf16_f32 v168, v96, v97
  v_cvt_pk_bf16_f32 v169, v98, v99
  v_cvt_pk_bf16_f32 v170, v100, v101
  v_cvt_pk_bf16_f32 v171, v102, v103
  v_exp_f32 v104, v104
  v_exp_f32 v105, v105
  v_mfma_f32_32x32x16_bf16 v[64:79], v[184:187], v[168:171], v[64:79]
  v_exp_f32 v106, v106
  v_exp_f32 v107, v107
  v_exp_f32 v108, v108
  v_exp_f32 v109, v109
  v_exp_f32 v110, v110
  v_exp_f32 v111, v111
  v_cvt_pk_bf16_f32 v172, v104, v105
  v_cvt_pk_bf16_f32 v173, v106, v107
  v_cvt_pk_bf16_f32 v174, v108, v109
  v_cvt_pk_bf16_f32 v175, v110, v111
  s_nop 1
  v_mfma_f32_32x32x16_bf16 v[64:79], v[188:191], v[172:175], v[64:79]
  s_waitcnt vmcnt(0)
  s_mov_b64 exec, 1
  ds_add_u32 v212, v213
  s_mov_b64 exec, -1
  s_lshl_b32 s28, s24, 12
  s_add_u32 m0, s28, 131072
  s_mul_i32 s96, s97, 524288
  buffer_load_dwordx4 v240, s[16:19], s96 offen offset:0 lds
  buffer_load_dwordx4 v241, s[16:19], s96 offen offset:1024 lds
  buffer_load_dwordx4 v242, s[16:19], s96 offen offset:2048 lds
  buffer_load_dwordx4 v243, s[16:19], s96 offen offset:3072 lds
  s_lshl_b32 s28, s24, 12
  s_add_u32 m0, s28, 147456
  s_add_u32 s96, s96, 524288
  s_cmp_eq_u32 s96, 5767168
  s_cselect_b32 s96, 0, s96
  buffer_load_dwordx4 v240, s[16:19], s96 offen offset:0 lds
  buffer_load_dwordx4 v241, s[16:19], s96 offen offset:1024 lds
  buffer_load_dwordx4 v242, s[16:19], s96 offen offset:2048 lds
  buffer_load_dwordx4 v243, s[16:19], s96 offen offset:3072 lds
  s_mov_b32 s93, 0
A_hs0:
  ds_read_b32 v214, v212
  s_add_u32 s93, s93, 1
  s_waitcnt lgkmcnt(0)
  v_readfirstlane_b32 s28, v214
  s_cmp_ge_u32 s93, 800000
  s_cbranch_scc1 A_hs0_ok
  s_nop 1
  s_cmp_ge_u32 s28, 4
  s_cbranch_scc1 A_hs0_ok
  s_sleep 1
  s_branch A_hs0
A_hs0_ok:
  ds_read_b128 v[152:155], v4 offset:7168
  ds_read_b128 v[156:159], v4 offset:19456
  ds_read_b128 v[144:147], v4 offset:6144
  ds_read_b128 v[148:151], v4 offset:18432
  s_mov_b64 exec, s[4:5]
  ds_read_b128 v[192:195], v5 offset:14336
  ds_read_b128 v[196:199], v5 offset:15360
  s_mov_b64 exec, s[6:7]
  ds_read_b128 v[200:203], v5 offset:14336
  ds_read_b128 v[204:207], v5 offset:15360
  s_mov_b64 exec, -1
  s_waitcnt lgkmcnt(6)
  v_mfma_f32_32x32x16_bf16 v[112:127], v[152:155], v[8:11], v[16:31]
  v_mfma_f32_32x32x16_bf16 v[128:143], v[156:159], v[12:15], v[32:47]
  s_branch A_p2_it1
A_p2_hw1:
  s_waitcnt lgkmcnt(0)
  s_waitcnt vmcnt(0)
  s_mov_b64 exec, 1
  ds_add_u32 v212, v213
  s_mov_b64 exec, -1
  v_exp_f32 v112, v112
  v_exp_f32 v113, v113
  v_exp_f32 v114, v114
  v_exp_f32 v115, v115
  v_exp_f32 v116, v116
  v_exp_f32 v117, v117
  v_exp_f32 v118, v118
  v_exp_f32 v119, v119
  v_cvt_pk_bf16_f32 v160, v112, v113
  v_cvt_pk_bf16_f32 v161, v114, v115
  v_cvt_pk_bf16_f32 v162, v116, v117
  v_cvt_pk_bf16_f32 v163, v118, v119
  v_exp_f32 v120, v120
  v_exp_f32 v121, v121
  v_mfma_f32_32x32x16_bf16 v[48:63], v[192:195], v[160:163], v[48:63]
  v_exp_f32 v122, v122
  v_exp_f32 v123, v123
  v_exp_f32 v124, v124
  v_exp_f32 v125, v125
  v_exp_f32 v126, v126
  v_exp_f32 v127, v127
  v_cvt_pk_bf16_f32 v164, v120, v121
  v_cvt_pk_bf16_f32 v165, v122, v123
  v_cvt_pk_bf16_f32 v166, v124, v125
  v_cvt_pk_bf16_f32 v167, v126, v127
  v_exp_f32 v128, v128
  v_exp_f32 v129, v129
  v_mfma_f32_32x32x16_bf16 v[48:63], v[196:199], v[164:167], v[48:63]
  v_exp_f32 v130, v130
  v_exp_f32 v131, v131
  v_exp_f32 v132, v132
  v_exp_f32 v133, v133
  v_exp_f32 v134, v134
  v_exp_f32 v135, v135
  v_cvt_pk_bf16_f32 v168, v128, v129
  v_cvt_pk_bf16_f32 v169, v130, v131
  v_cvt_pk_bf16_f32 v170, v132, v133
  v_cvt_pk_bf16_f32 v171, v134, v135
  v_exp_f32 v136, v136
  v_exp_f32 v137, v137
  v_mfma_f32_32x32x16_bf16 v[64:79], v[200:203], v[168:171], v[64:79]
  v_exp_f32 v138, v138
  v_exp_f32 v139, v139
  v_exp_f32 v140, v140
  v_exp_f32 v141, v141
  v_exp_f32 v142, v142
  v_exp_f32 v143, v143
  v_cvt_pk_bf16_f32 v172, v136, v137
  v_cvt_pk_bf16_f32 v173, v138, v139
  v_cvt_pk_bf16_f32 v174, v140, v141
  v_cvt_pk_bf16_f32 v175, v142, v143
  s_nop 1
  v_mfma_f32_32x32x16_bf16 v[64:79], v[204:207], v[172:175], v[64:79]
  s_lshl_b32 s28, s24, 12
  s_add_u32 m0, s28, 131072
  s_mul_i32 s96, s97, 524288
  buffer_load_dwordx4 v240, s[16:19], s96 offen offset:0 lds
  buffer_load_dwordx4 v241, s[16:19], s96 offen offset:1024 lds
  buffer_load_dwordx4 v242, s[16:19], s96 offen offset:2048 lds
  buffer_load_dwordx4 v243, s[16:19], s96 offen offset:3072 lds
  s_lshl_b32 s28, s24, 12
  s_add_u32 m0, s28, 147456
  s_add_u32 s96, s96, 524288
  s_cmp_eq_u32 s96, 5767168
  s_cselect_b32 s96, 0, s96
  buffer_load_dwordx4 v240, s[16:19], s96 offen offset:0 lds
  buffer_load_dwordx4 v241, s[16:19], s96 offen offset:1024 lds
  buffer_load_dwordx4 v242, s[16:19], s96 offen offset:2048 lds
  buffer_load_dwordx4 v243, s[16:19], s96 offen offset:3072 lds
  s_mov_b32 s93, 0
A_hs1:
  ds_read_b32 v214, v212
  s_add_u32 s93, s93, 1
  s_waitcnt lgkmcnt(0)
  v_readfirstlane_b32 s28, v214
  s_cmp_ge_u32 s93, 800000
  s_cbranch_scc1 A_hs1_ok
  s_nop 1
  s_cmp_ge_u32 s28, 4
  s_cbranch_scc1 A_hs1_ok
  s_sleep 1
  s_branch A_hs1
A_hs1_ok:
  ds_read_b128 v[144:147], v4 offset:6144
  ds_read_b128 v[148:151], v4 offset:18432
  ds_read_b128 v[152:155], v4 offset:5120
  ds_read_b128 v[156:159], v4 offset:17408
  s_mov_b64 exec, s[4:5]
  ds_read_b128 v[176:179], v5 offset:12288
  ds_read_b128 v[180:183], v5 offset:13312
  s_mov_b64 exec, s[6:7]
  ds_read_b128 v[184:187], v5 offset:12288
  ds_read_b128 v[188:191], v5 offset:13312
  s_mov_b64 exec, -1
  s_waitcnt lgkmcnt(6)
  v_mfma_f32_32x32x16_bf16 v[80:95], v[144:147], v[8:11], v[16:31]
  v_mfma_f32_32x32x16_bf16 v[96:111], v[148:151], v[12:15], v[32:47]
  s_branch A_p2_it2
A_p2_hw2:
  s_waitcnt lgkmcnt(0)
  v_exp_f32 v80, v80
  v_exp_f32 v81, v81
  v_exp_f32 v82, v82
  v_exp_f32 v83, v83
  v_exp_f32 v84, v84
  v_exp_f32 v85, v85
  v_exp_f32 v86, v86
  v_exp_f32 v87, v87
  v_cvt_pk_bf16_f32 v160, v80, v81
  v_cvt_pk_bf16_f32 v161, v82, v83
  v_cvt_pk_bf16_f32 v162, v84, v85
  v_cvt_pk_bf16_f32 v163, v86, v87
  v_exp_f32 v88, v88
  v_exp_f32 v89, v89
  v_mfma_f32_32x32x16_bf16 v[48:63], v[176:179], v[160:163], v[48:63]
  v_exp_f32 v90, v90
  v_exp_f32 v91, v91
  v_exp_f32 v92, v92
  v_exp_f32 v93, v93
  v_exp_f32 v94, v94
  v_exp_f32 v95, v95
  v_cvt_pk_bf16_f32 v164, v88, v89
  v_cvt_pk_bf16_f32 v165, v90, v91
  v_cvt_pk_bf16_f32 v166, v92, v93
  v_cvt_pk_bf16_f32 v167, v94, v95
  v_exp_f32 v96, v96
  v_exp_f32 v97, v97
  v_mfma_f32_32x32x16_bf16 v[48:63], v[180:183], v[164:167], v[48:63]
  v_exp_f32 v98, v98
  v_exp_f32 v99, v99
  v_exp_f32 v100, v100
  v_exp_f32 v101, v101
  v_exp_f32 v102, v102
  v_exp_f32 v103, v103
  v_cvt_pk_bf16_f32 v168, v96, v97
  v_cvt_pk_bf16_f32 v169, v98, v99
  v_cvt_pk_bf16_f32 v170, v100, v101
  v_cvt_pk_bf16_f32 v171, v102, v103
  v_exp_f32 v104, v104
  v_exp_f32 v105, v105
  v_mfma_f32_32x32x16_bf16 v[64:79], v[184:187], v[168:171], v[64:79]
  v_exp_f32 v106, v106
  v_exp_f32 v107, v107
  v_exp_f32 v108, v108
  v_exp_f32 v109, v109
  v_exp_f32 v110, v110
  v_exp_f32 v111, v111
  v_cvt_pk_bf16_f32 v172, v104, v105
  v_cvt_pk_bf16_f32 v173, v106, v107
  v_cvt_pk_bf16_f32 v174, v108, v109
  v_cvt_pk_bf16_f32 v175, v110, v111
  s_nop 1
  v_mfma_f32_32x32x16_bf16 v[64:79], v[188:191], v[172:175], v[64:79]
  s_mov_b32 s93, 0
A_hs2:
  ds_read_b32 v214, v212
  s_add_u32 s93, s93, 1
  s_waitcnt lgkmcnt(0)
  v_readfirstlane_b32 s28, v214
  s_cmp_ge_u32 s93, 800000
  s_cbranch_scc1 A_hs2_ok
  s_nop 1
  s_cmp_ge_u32 s28, 4
  s_cbranch_scc1 A_hs2_ok
  s_sleep 1
  s_branch A_hs2
A_hs2_ok:
  ds_read_b128 v[152:155], v4 offset:5120
  ds_read_b128 v[156:159], v4 offset:17408
  ds_read_b128 v[144:147], v4 offset:4096
  ds_read_b128 v[148:151], v4 offset:16384
  s_mov_b64 exec, s[4:5]
  ds_read_b128 v[192:195], v5 offset:10240
  ds_read_b128 v[196:199], v5 offset:11264
  s_mov_b64 exec, s[6:7]
  ds_read_b128 v[200:203], v5 offset:10240
  ds_read_b128 v[204:207], v5 offset:11264
  s_mov_b64 exec, -1
  s_waitcnt lgkmcnt(6)
  v_mfma_f32_32x32x16_bf16 v[112:127], v[152:155], v[8:11], v[16:31]
  v_mfma_f32_32x32x16_bf16 v[128:143], v[156:159], v[12:15], v[32:47]
  s_branch A_p2_it3
A_p2_hw3:
  s_waitcnt lgkmcnt(0)
  v_exp_f32 v112, v112
  v_exp_f32 v113, v113
  v_exp_f32 v114, v114
  v_exp_f32 v115, v115
  v_exp_f32 v116, v116
  v_exp_f32 v117, v117
  v_exp_f32 v118, v118
  v_exp_f32 v119, v119
  v_cvt_pk_bf16_f32 v160, v112, v113
  v_cvt_pk_bf16_f32 v161, v114, v115
  v_cvt_pk_bf16_f32 v162, v116, v117
  v_cvt_pk_bf16_f32 v163, v118, v119
  v_exp_f32 v120, v120
  v_exp_f32 v121, v121
  v_mfma_f32_32x32x16_bf16 v[48:63], v[192:195], v[160:163], v[48:63]
  v_exp_f32 v122, v122
  v_exp_f32 v123, v123
  v_exp_f32 v124, v124
  v_exp_f32 v125, v125
  v_exp_f32 v126, v126
  v_exp_f32 v127, v127
  v_cvt_pk_bf16_f32 v164, v120, v121
  v_cvt_pk_bf16_f32 v165, v122, v123
  v_cvt_pk_bf16_f32 v166, v124, v125
  v_cvt_pk_bf16_f32 v167, v126, v127
  v_exp_f32 v128, v128
  v_exp_f32 v129, v129
  v_mfma_f32_32x32x16_bf16 v[48:63], v[196:199], v[164:167], v[48:63]
  v_exp_f32 v130, v130
  v_exp_f32 v131, v131
  v_exp_f32 v132, v132
  v_exp_f32 v133, v133
  v_exp_f32 v134, v134
  v_exp_f32 v135, v135
  v_cvt_pk_bf16_f32 v168, v128, v129
  v_cvt_pk_bf16_f32 v169, v130, v131
  v_cvt_pk_bf16_f32 v170, v132, v133
  v_cvt_pk_bf16_f32 v171, v134, v135
  v_exp_f32 v136, v136
  v_exp_f32 v137, v137
  v_mfma_f32_32x32x16_bf16 v[64:79], v[200:203], v[168:171], v[64:79]
  v_exp_f32 v138, v138
  v_exp_f32 v139, v139
  v_exp_f32 v140, v140
  v_exp_f32 v141, v141
  v_exp_f32 v142, v142
  v_exp_f32 v143, v143
  v_cvt_pk_bf16_f32 v172, v136, v137
  v_cvt_pk_bf16_f32 v173, v138, v139
  v_cvt_pk_bf16_f32 v174, v140, v141
  v_cvt_pk_bf16_f32 v175, v142, v143
  s_nop 1
  v_mfma_f32_32x32x16_bf16 v[64:79], v[204:207], v[172:175], v[64:79]
  s_mov_b32 s93, 0
A_hs3:
  ds_read_b32 v214, v212
  s_add_u32 s93, s93, 1
  s_waitcnt lgkmcnt(0)
  v_readfirstlane_b32 s28, v214
  s_cmp_ge_u32 s93, 800000
  s_cbranch_scc1 A_hs3_ok
  s_nop 1
  s_cmp_ge_u32 s28, 4
  s_cbranch_scc1 A_hs3_ok
  s_sleep 1
  s_branch A_hs3
A_hs3_ok:
  ds_read_b128 v[144:147], v4 offset:4096
  ds_read_b128 v[148:151], v4 offset:16384
  ds_read_b128 v[152:155], v4 offset:3072
  ds_read_b128 v[156:159], v4 offset:15360
  s_mov_b64 exec, s[4:5]
  ds_read_b128 v[176:179], v5 offset:8192
  ds_read_b128 v[180:183], v5 offset:9216
  s_mov_b64 exec, s[6:7]
  ds_read_b128 v[184:187], v5 offset:8192
  ds_read_b128 v[188:191], v5 offset:9216
  s_mov_b64 exec, -1
  s_waitcnt lgkmcnt(6)
  v_mfma_f32_32x32x16_bf16 v[80:95], v[144:147], v[8:11], v[16:31]
  v_mfma_f32_32x32x16_bf16 v[96:111], v[148:151], v[12:15], v[32:47]
  s_branch A_p2_it4
A_p2_last1:
  s_waitcnt lgkmcnt(0)
  s_nop 7
  s_nop 3
  v_exp_f32 v112, v112
  v_exp_f32 v113, v113
  v_exp_f32 v114, v114
  v_exp_f32 v115, v115
  v_exp_f32 v116, v116
  v_exp_f32 v117, v117
  v_exp_f32 v118, v118
  v_exp_f32 v119, v119
  v_cvt_pk_bf16_f32 v160, v112, v113
  v_cvt_pk_bf16_f32 v161, v114, v115
  v_cvt_pk_bf16_f32 v162, v116, v117
  v_cvt_pk_bf16_f32 v163, v118, v119
  v_exp_f32 v120, v120
  v_exp_f32 v121, v121
  v_mfma_f32_32x32x16_bf16 v[48:63], v[192:195], v[160:163], v[48:63]
  v_exp_f32 v122, v122
  v_exp_f32 v123, v123
  v_exp_f32 v124, v124
  v_exp_f32 v125, v125
  v_exp_f32 v126, v126
  v_exp_f32 v127, v127
  v_cvt_pk_bf16_f32 v164, v120, v121
  v_cvt_pk_bf16_f32 v165, v122, v123
  v_cvt_pk_bf16_f32 v166, v124, v125
  v_cvt_pk_bf16_f32 v167, v126, v127
  v_exp_f32 v128, v128
  v_exp_f32 v129, v129
  v_mfma_f32_32x32x16_bf16 v[48:63], v[196:199], v[164:167], v[48:63]
  v_exp_f32 v130, v130
  v_exp_f32 v131, v131
  v_exp_f32 v132, v132
  v_exp_f32 v133, v133
  v_exp_f32 v134, v134
  v_exp_f32 v135, v135
  v_cvt_pk_bf16_f32 v168, v128, v129
  v_cvt_pk_bf16_f32 v169, v130, v131
  v_cvt_pk_bf16_f32 v170, v132, v133
  v_cvt_pk_bf16_f32 v171, v134, v135
  v_exp_f32 v136, v136
  v_exp_f32 v137, v137
  v_mfma_f32_32x32x16_bf16 v[64:79], v[200:203], v[168:171], v[64:79]
  v_exp_f32 v138, v138
  v_exp_f32 v139, v139
  v_exp_f32 v140, v140
  v_exp_f32 v141, v141
  v_exp_f32 v142, v142
  v_exp_f32 v143, v143
  v_cvt_pk_bf16_f32 v172, v136, v137
  v_cvt_pk_bf16_f32 v173, v138, v139
  v_cvt_pk_bf16_f32 v174, v140, v141
  v_cvt_pk_bf16_f32 v175, v142, v143
  s_nop 1
  v_mfma_f32_32x32x16_bf16 v[64:79], v[204:207], v[172:175], v[64:79]
A_p2_done:
  s_lshl_b32 s28, s94, 1
  s_add_u32 s28, s28, s91
  s_lshl_b32 s86, s92, 15
  s_lshl_b32 s87, s28, 11
  s_add_u32 s86, s86, s87
  s_add_u32 s86, s86, 8388608
  v_add_u32 v2, s86, v3
  s_lshl_b32 s86, s92, 4
  s_add_u32 s86, s86, s28
  s_lshl_b32 s86, s86, 7
  s_add_u32 s86, s86, 10719232
  v_mov_b32 v210, 0x5f800000
  v_max_f32 v211, v56, v64
  v_add_f32 v209, v56, v64
  v_cmp_u_f32 vcc, v209, v209
  v_cmp_ngt_f32 s[10:11], v210, v211
  s_nop 3
  s_or_b64 vcc, vcc, s[10:11]
  s_cbranch_vccz A_fin
  s_cmp_eq_u32 s89, s90
  s_cbranch_scc1 A_fin
  s_mov_b32 s89, s90
  s_mov_b32 s8, 99
  s_mov_b32 s10, 0
  s_branch A_p1
A_fin:
  v_mov_b32 v4, s86
  v_mov_b32 v5, s31
  v_rcp_f32 v208, v56
  v_rcp_f32 v210, v64
  v_pk_mul_f32 v[48:49], v[48:49], v[208:209] op_sel_hi:[1,0]
  v_pk_mul_f32 v[50:51], v[50:51], v[208:209] op_sel_hi:[1,0]
  v_pk_mul_f32 v[52:53], v[52:53], v[208:209] op_sel_hi:[1,0]
  v_pk_mul_f32 v[54:55], v[54:55], v[208:209] op_sel_hi:[1,0]
  v_pk_mul_f32 v[72:73], v[72:73], v[210:211] op_sel_hi:[1,0]
  v_pk_mul_f32 v[74:75], v[74:75], v[210:211] op_sel_hi:[1,0]
  v_pk_mul_f32 v[76:77], v[76:77], v[210:211] op_sel_hi:[1,0]
  v_pk_mul_f32 v[78:79], v[78:79], v[210:211] op_sel_hi:[1,0]
  v_cvt_pk_bf16_f32 v160, v48, v49
  v_cvt_pk_bf16_f32 v161, v50, v51
  v_cvt_pk_bf16_f32 v162, v52, v53
  v_cvt_pk_bf16_f32 v163, v54, v55
  v_cvt_pk_bf16_f32 v164, v72, v73
  v_cvt_pk_bf16_f32 v165, v74, v75
  v_cvt_pk_bf16_f32 v166, v76, v77
  v_cvt_pk_bf16_f32 v167, v78, v79
  buffer_store_dwordx4 v[160:163], v2, s[12:15], 0 offen sc1
  buffer_store_dwordx4 v[164:167], v2, s[12:15], 0 offen offset:1024 sc1
  s_barrier
  v_mov_b32 v252, v4
  v_mov_b32 v253, v5
  s_cmp_lt_u32 s3, 4
  s_cbranch_scc1 F_cons2
  s_waitcnt vmcnt(0)
  s_mov_b64 exec, 1
  buffer_store_dword v5, v4, s[12:15], 0 offen sc1
  s_mov_b64 exec, -1
  s_cmp_lt_u32 s3, 4
  s_cbranch_scc0 F_load
  s_branch F_cons2
B_entry:
  s_lshl_b32 s28, s25, 4
  s_add_u32 s28, s28, s27
  s_lshr_b32 s94, s28, 2
  s_and_b32 s28, s28, 3
  s_lshl_b32 s95, s26, 2
  s_add_u32 s95, s95, s28
  s_add_u32 s98, s94, s95
  s_and_b32 s98, s98, 3
  s_mul_i32 s98, s98, 2
  s_cmp_lt_u32 s3, 4
  s_cbranch_scc1 B_cons
  v_add_u32 v10, 0, v1
  v_mul_u32_u24 v11, 5462, v10
  v_lshrrev_b32 v11, 16, v11
  v_mul_u32_u24 v12, 12, v11
  v_sub_u32 v12, v10, v12
  s_lshl_b32 s28, s24, 5
  v_add_u32 v11, s28, v11
  v_mul_u32_u24 v11, 2752, v11
  v_lshl_add_u32 v11, v12, 4, v11
  s_mul_i32 s28, s94, 192
  s_sub_u32 s28, s28, 0
  v_add_u32 v2, s28, v11
  s_cmp_eq_u32 s94, 14
  s_cselect_b32 s28, 4, 12
  v_cmp_le_u32 vcc, s28, v12
  v_mov_b32 v13, 0x7fff0000
  s_nop 0
  v_cndmask_b32 v2, v2, v13, vcc
  v_add_u32 v5, 44032, v2
  v_add_u32 v10, 64, v1
  v_mul_u32_u24 v11, 5462, v10
  v_lshrrev_b32 v11, 16, v11
  v_mul_u32_u24 v12, 12, v11
  v_sub_u32 v12, v10, v12
  s_lshl_b32 s28, s24, 5
  v_add_u32 v11, s28, v11
  v_mul_u32_u24 v11, 2752, v11
  v_lshl_add_u32 v11, v12, 4, v11
  s_mul_i32 s28, s94, 192
  s_sub_u32 s28, s28, 1024
  v_add_u32 v3, s28, v11
  s_cmp_eq_u32 s94, 14
  s_cselect_b32 s28, 4, 12
  v_cmp_le_u32 vcc, s28, v12
  v_mov_b32 v13, 0x7fff0000
  s_nop 0
  v_cndmask_b32 v3, v3, v13, vcc
  v_add_u32 v6, 44032, v3
  v_add_u32 v10, 128, v1
  v_mul_u32_u24 v11, 5462, v10
  v_lshrrev_b32 v11, 16, v11
  v_mul_u32_u24 v12, 12, v11
  v_sub_u32 v12, v10, v12
  s_lshl_b32 s28, s24, 5
  v_add_u32 v11, s28, v11
  v_mul_u32_u24 v11, 2752, v11
  v_lshl_add_u32 v11, v12, 4, v11
  s_mul_i32 s28, s94, 192
  s_sub_u32 s28, s28, 2048
  v_add_u32 v4, s28, v11
  s_cmp_eq_u32 s94, 14
  s_cselect_b32 s28, 4, 12
  v_cmp_le_u32 vcc, s28, v12
  v_mov_b32 v13, 0x7fff0000
  s_nop 0
  v_cndmask_b32 v4, v4, v13, vcc
  v_add_u32 v7, 44032, v4
  s_mul_i32 s89, s24, 6144
  s_waitcnt lgkmcnt(0)
  s_mov_b32 s4, s72
  s_mov_b32 s5, s73
  s_mov_b32 s6, 5636096
  s_mov_b32 s7, 0x00020000
  s_mov_b32 s12, s84
  s_mov_b32 s13, s85
  s_mov_b32 s14, 10850304
  s_mov_b32 s15, 0x00020000
  s_mov_b32 s31, 0
  s_cmp_eq_u32 s94, 15
  s_cbranch_scc1 B_l_spare
  s_barrier
  s_add_u32 m0, s89, 0
  s_add_u32 s90, s98, 0
  s_and_b32 s90, s90, 7
  s_add_u32 s90, s90, 0
  s_mul_i32 s90, s90, 352256
  buffer_load_dwordx4 v2, s[4:7], s90 offen offset:0 lds
  buffer_load_dwordx4 v3, s[4:7], s90 offen offset:1024 lds
  buffer_load_dwordx4 v4, s[4:7], s90 offen offset:2048 lds
  s_add_u32 m0, s89, 3072
  s_nop 0
  buffer_load_dwordx4 v5, s[4:7], s90 offen offset:0 lds
  buffer_load_dwordx4 v6, s[4:7], s90 offen offset:1024 lds
  buffer_load_dwordx4 v7, s[4:7], s90 offen offset:2048 lds
  s_mov_b32 s16, s76
  s_mov_b32 s17, s77
  s_mov_b32 s18, 5636096
  s_mov_b32 s19, 0x00020000
  s_mov_b32 s20, s68
  s_mov_b32 s21, s69
  s_mov_b32 s22, 524288
  s_mov_b32 s23, 0x00020000
  v_lshrrev_b32 v248, 3, v1
  s_lshl_b32 s28, s24, 5
  v_add_u32 v248, s28, v248
  v_bfe_u32 v249, v1, 4, 1
  v_lshlrev_b32 v249, 2, v249
  v_and_b32 v250, 7, v1
  v_xor_b32 v249, v249, v250
  v_lshlrev_b32 v249, 4, v249
  s_lshl_b32 s28, s29, 7
  v_mul_u32_u24 v240, 4096, v248
  v_add3_u32 v240, v240, v249, s28
  v_add_u32 v241, 31744, v240
  v_add_u32 v242, 63488, v240
  v_add_u32 v243, 95232, v240
  s_lshl_b32 s28, s30, 7
  v_mul_u32_u24 v244, 1024, v248
  v_add3_u32 v244, v244, v249, s28
  v_add_u32 v245, 7168, v244
  v_add_u32 v246, 14336, v244
  v_add_u32 v247, 21504, v244
  s_barrier
  s_add_u32 m0, s89, 24576
  s_add_u32 s90, s98, 1
  s_and_b32 s90, s90, 7
  s_add_u32 s90, s90, 0
  s_mul_i32 s90, s90, 352256
  buffer_load_dwordx4 v2, s[4:7], s90 offen offset:0 lds
  buffer_load_dwordx4 v3, s[4:7], s90 offen offset:1024 lds
  buffer_load_dwordx4 v4, s[4:7], s90 offen offset:2048 lds
  s_add_u32 m0, s89, 27648
  s_nop 0
  buffer_load_dwordx4 v5, s[4:7], s90 offen offset:0 lds
  buffer_load_dwordx4 v6, s[4:7], s90 offen offset:1024 lds
  buffer_load_dwordx4 v7, s[4:7], s90 offen offset:2048 lds
  s_waitcnt vmcnt(6)
  s_barrier
  s_add_u32 m0, s89, 49152
  s_add_u32 s90, s98, 2
  s_and_b32 s90, s90, 7
  s_add_u32 s90, s90, 0
  s_mul_i32 s90, s90, 352256
  buffer_load_dwordx4 v2, s[4:7], s90 offen offset:0 lds
  buffer_load_dwordx4 v3, s[4:7], s90 offen offset:1024 lds
  buffer_load_dwordx4 v4, s[4:7], s90 offen offset:2048 lds
  s_add_u32 m0, s89, 52224
  s_nop 0
  buffer_load_dwordx4 v5, s[4:7], s90 offen offset:0 lds
  buffer_load_dwordx4 v6, s[4:7], s90 offen offset:1024 lds
  buffer_load_dwordx4 v7, s[4:7], s90 offen offset:2048 lds
  s_waitcnt vmcnt(6)
  s_barrier
  s_add_u32 m0, s89, 73728
  s_add_u32 s90, s98, 3
  s_and_b32 s90, s90, 7
  s_add_u32 s90, s90, 0
  s_mul_i32 s90, s90, 352256
  buffer_load_dwordx4 v2, s[4:7], s90 offen offset:0 lds
  buffer_load_dwordx4 v3, s[4:7], s90 offen offset:1024 lds
  buffer_load_dwordx4 v4, s[4:7], s90 offen offset:2048 lds
  s_add_u32 m0, s89, 76800
  s_nop 0
  buffer_load_dwordx4 v5, s[4:7], s90 offen offset:0 lds
  buffer_load_dwordx4 v6, s[4:7], s90 offen offset:1024 lds
  buffer_load_dwordx4 v7, s[4:7], s90 offen offset:2048 lds
  s_waitcnt vmcnt(6)
  s_barrier
  s_add_u32 m0, s89, 98304
  s_add_u32 s90, s98, 4
  s_and_b32 s90, s90, 7
  s_add_u32 s90, s90, 0
  s_mul_i32 s90, s90, 352256
  buffer_load_dwordx4 v2, s[4:7], s90 offen offset:0 lds
  buffer_load_dwordx4 v3, s[4:7], s90 offen offset:1024 lds
  buffer_load_dwordx4 v4, s[4:7], s90 offen offset:2048 lds
  s_add_u32 m0, s89, 101376
  s_nop 0
  buffer_load_dwordx4 v5, s[4:7], s90 offen offset:0 lds
  buffer_load_dwordx4 v6, s[4:7], s90 offen offset:1024 lds
  s_waitcnt vmcnt(5)
  s_barrier
  buffer_load_dwordx4 v7, s[4:7], s90 offen offset:2048 lds
  s_add_u32 m0, s89, 122880
  s_add_u32 s90, s98, 5
  s_and_b32 s90, s90, 7
  s_add_u32 s90, s90, 0
  s_mul_i32 s90, s90, 352256
  buffer_load_dwordx4 v2, s[4:7], s90 offen offset:0 lds
  buffer_load_dwordx4 v3, s[4:7], s90 offen offset:1024 lds
  buffer_load_dwordx4 v4, s[4:7], s90 offen offset:2048 lds
  s_add_u32 m0, s89, 125952
  s_nop 0
  buffer_load_dwordx4 v5, s[4:7], s90 offen offset:0 lds
  buffer_load_dwordx4 v6, s[4:7], s90 offen offset:1024 lds
  s_waitcnt vmcnt(5)
  s_barrier
  buffer_load_dwordx4 v7, s[4:7], s90 offen offset:2048 lds
  s_add_u32 m0, s89, 0
  s_add_u32 s90, s98, 6
  s_and_b32 s90, s90, 7
  s_add_u32 s90, s90, 0
  s_mul_i32 s90, s90, 352256
  buffer_load_dwordx4 v2, s[4:7], s90 offen offset:0 lds
  buffer_load_dwordx4 v3, s[4:7], s90 offen offset:1024 lds
  buffer_load_dwordx4 v4, s[4:7], s90 offen offset:2048 lds
  s_add_u32 m0, s89, 3072
  s_nop 0
  buffer_load_dwordx4 v5, s[4:7], s90 offen offset:0 lds
  s_waitcnt vmcnt(4)
  s_barrier
  buffer_load_dwordx4 v6, s[4:7], s90 offen offset:1024 lds
  buffer_load_dwordx4 v7, s[4:7], s90 offen offset:2048 lds
  s_add_u32 m0, s89, 24576
  s_add_u32 s90, s98, 7
  s_and_b32 s90, s90, 7
  s_add_u32 s90, s90, 0
  s_mul_i32 s90, s90, 352256
  buffer_load_dwordx4 v2, s[4:7], s90 offen offset:0 lds
  buffer_load_dwordx4 v3, s[4:7], s90 offen offset:1024 lds
  buffer_load_dwordx4 v4, s[4:7], s90 offen offset:2048 lds
  s_add_u32 m0, s89, 27648
  s_nop 0
  buffer_load_dwordx4 v5, s[4:7], s90 offen offset:0 lds
  s_waitcnt vmcnt(4)
  s_barrier
  buffer_load_dwordx4 v6, s[4:7], s90 offen offset:1024 lds
  buffer_load_dwordx4 v7, s[4:7], s90 offen offset:2048 lds
  s_add_u32 m0, s89, 49152
  s_add_u32 s90, s98, 0
  s_and_b32 s90, s90, 7
  s_add_u32 s90, s90, 8
  s_mul_i32 s90, s90, 352256
  buffer_load_dwordx4 v2, s[4:7], s90 offen offset:0 lds
  buffer_load_dwordx4 v3, s[4:7], s90 offen offset:1024 lds
  buffer_load_dwordx4 v4, s[4:7], s90 offen offset:2048 lds
  s_add_u32 m0, s89, 52224
  s_nop 0
  buffer_load_dwordx4 v5, s[4:7], s90 offen offset:0 lds
  s_waitcnt vmcnt(4)
  s_barrier
  buffer_load_dwordx4 v6, s[4:7], s90 offen offset:1024 lds
  buffer_load_dwordx4 v7, s[4:7], s90 offen offset:2048 lds
  s_add_u32 m0, s89, 73728
  s_add_u32 s90, s98, 1
  s_and_b32 s90, s90, 7
  s_add_u32 s90, s90, 8
  s_mul_i32 s90, s90, 352256
  buffer_load_dwordx4 v2, s[4:7], s90 offen offset:0 lds
  buffer_load_dwordx4 v3, s[4:7], s90 offen offset:1024 lds
  buffer_load_dwordx4 v4, s[4:7], s90 offen offset:2048 lds
  s_waitcnt vmcnt(3)
  s_barrier
  s_add_u32 m0, s89, 76800
  s_nop 0
  buffer_load_dwordx4 v5, s[4:7], s90 offen offset:0 lds
  buffer_load_dwordx4 v6, s[4:7], s90 offen offset:1024 lds
  buffer_load_dwordx4 v7, s[4:7], s90 offen offset:2048 lds
  s_add_u32 m0, s89, 98304
  s_add_u32 s90, s98, 2
  s_and_b32 s90, s90, 7
  s_add_u32 s90, s90, 8
  s_mul_i32 s90, s90, 352256
  buffer_load_dwordx4 v2, s[4:7], s90 offen offset:0 lds
  buffer_load_dwordx4 v3, s[4:7], s90 offen offset:1024 lds
  buffer_load_dwordx4 v4, s[4:7], s90 offen offset:2048 lds
  s_waitcnt vmcnt(3)
  s_barrier
  s_add_u32 m0, s89, 101376
  s_nop 0
  buffer_load_dwordx4 v5, s[4:7], s90 offen offset:0 lds
  buffer_load_dwordx4 v6, s[4:7], s90 offen offset:1024 lds
  buffer_load_dwordx4 v7, s[4:7], s90 offen offset:2048 lds
  s_add_u32 m0, s89, 122880
  s_add_u32 s90, s98, 3
  s_and_b32 s90, s90, 7
  s_add_u32 s90, s90, 8
  s_mul_i32 s90, s90, 352256
  buffer_load_dwordx4 v2, s[4:7], s90 offen offset:0 lds
  buffer_load_dwordx4 v3, s[4:7], s90 offen offset:1024 lds
  s_waitcnt vmcnt(2)
  s_barrier
  buffer_load_dwordx4 v4, s[4:7], s90 offen offset:2048 lds
  s_add_u32 m0, s89, 125952
  s_nop 0
  buffer_load_dwordx4 v5, s[4:7], s90 offen offset:0 lds
  buffer_load_dwordx4 v6, s[4:7], s90 offen offset:1024 lds
  buffer_load_dwordx4 v7, s[4:7], s90 offen offset:2048 lds
  s_add_u32 m0, s89, 0
  s_add_u32 s90, s98, 4
  s_and_b32 s90, s90, 7
  s_add_u32 s90, s90, 8
  s_mul_i32 s90, s90, 352256
  buffer_load_dwordx4 v2, s[4:7], s90 offen offset:0 lds
  buffer_load_dwordx4 v3, s[4:7], s90 offen offset:1024 lds
  s_waitcnt vmcnt(2)
  s_barrier
  buffer_load_dwordx4 v4, s[4:7], s90 offen offset:2048 lds
  s_add_u32 m0, s89, 3072
  s_nop 0
  buffer_load_dwordx4 v5, s[4:7], s90 offen offset:0 lds
  buffer_load_dwordx4 v6, s[4:7], s90 offen offset:1024 lds
  buffer_load_dwordx4 v7, s[4:7], s90 offen offset:2048 lds
  s_add_u32 m0, s89, 24576
  s_add_u32 s90, s98, 5
  s_and_b32 s90, s90, 7
  s_add_u32 s90, s90, 8
  s_mul_i32 s90, s90, 352256
  buffer_load_dwordx4 v2, s[4:7], s90 offen offset:0 lds
  buffer_load_dwordx4 v3, s[4:7], s90 offen offset:1024 lds
  s_waitcnt vmcnt(2)
  s_barrier
  buffer_load_dwordx4 v4, s[4:7], s90 offen offset:2048 lds
  s_add_u32 m0, s89, 27648
  s_nop 0
  buffer_load_dwordx4 v5, s[4:7], s90 offen offset:0 lds
  buffer_load_dwordx4 v6, s[4:7], s90 offen offset:1024 lds
  buffer_load_dwordx4 v7, s[4:7], s90 offen offset:2048 lds
  s_add_u32 m0, s89, 49152
  s_add_u32 s90, s98, 6
  s_and_b32 s90, s90, 7
  s_add_u32 s90, s90, 8
  s_mul_i32 s90, s90, 352256
  buffer_load_dwordx4 v2, s[4:7], s90 offen offset:0 lds
  s_waitcnt vmcnt(1)
  s_barrier
  buffer_load_dwordx4 v3, s[4:7], s90 offen offset:1024 lds
  buffer_load_dwordx4 v4, s[4:7], s90 offen offset:2048 lds
  s_add_u32 m0, s89, 52224
  s_nop 0
  buffer_load_dwordx4 v5, s[4:7], s90 offen offset:0 lds
  buffer_load_dwordx4 v6, s[4:7], s90 offen offset:1024 lds
  buffer_load_dwordx4 v7, s[4:7], s90 offen offset:2048 lds
  s_add_u32 m0, s89, 73728
  s_add_u32 s90, s98, 7
  s_and_b32 s90, s90, 7
  s_add_u32 s90, s90, 8
  s_mul_i32 s90, s90, 352256
  buffer_load_dwordx4 v2, s[4:7], s90 offen offset:0 lds
  s_waitcnt vmcnt(1)
  s_barrier
  buffer_load_dwordx4 v3, s[4:7], s90 offen offset:1024 lds
  buffer_load_dwordx4 v4, s[4:7], s90 offen offset:2048 lds
  s_add_u32 m0, s89, 76800
  s_nop 0
  buffer_load_dwordx4 v5, s[4:7], s90 offen offset:0 lds
  buffer_load_dwordx4 v6, s[4:7], s90 offen offset:1024 lds
  buffer_load_dwordx4 v7, s[4:7], s90 offen offset:2048 lds
  s_waitcnt vmcnt(0)
  s_barrier
  s_barrier
  s_barrier
  s_lshl_b32 s28, s24, 12
  s_add_u32 m0, s28, 131072
  s_mul_i32 s96, s97, 524288
  buffer_load_dwordx4 v240, s[16:19], s96 offen offset:0 lds
  buffer_load_dwordx4 v241, s[16:19], s96 offen offset:1024 lds
  buffer_load_dwordx4 v242, s[16:19], s96 offen offset:2048 lds
  buffer_load_dwordx4 v243, s[16:19], s96 offen offset:3072 lds
  s_lshl_b32 s28, s24, 12
  s_add_u32 m0, s28, 147456
  s_add_u32 s96, s96, 524288
  s_cmp_eq_u32 s96, 5767168
  s_cselect_b32 s96, 0, s96
  buffer_load_dwordx4 v240, s[16:19], s96 offen offset:0 lds
  buffer_load_dwordx4 v241, s[16:19], s96 offen offset:1024 lds
  buffer_load_dwordx4 v242, s[16:19], s96 offen offset:2048 lds
  buffer_load_dwordx4 v243, s[16:19], s96 offen offset:3072 lds
  s_lshl_b32 s28, s24, 12
  s_add_u32 m0, s28, 0
  s_add_u32 s96, s96, 524288
  s_cmp_eq_u32 s96, 5767168
  s_cselect_b32 s96, 0, s96
  buffer_load_dwordx4 v240, s[16:19], s96 offen offset:0 lds
  buffer_load_dwordx4 v241, s[16:19], s96 offen offset:1024 lds
  buffer_load_dwordx4 v242, s[16:19], s96 offen offset:2048 lds
  buffer_load_dwordx4 v243, s[16:19], s96 offen offset:3072 lds
  s_lshl_b32 s28, s24, 12
  s_add_u32 m0, s28, 16384
  s_add_u32 s96, s96, 524288
  s_cmp_eq_u32 s96, 5767168
  s_cselect_b32 s96, 0, s96
  buffer_load_dwordx4 v240, s[16:19], s96 offen offset:0 lds
  buffer_load_dwordx4 v241, s[16:19], s96 offen offset:1024 lds
  buffer_load_dwordx4 v242, s[16:19], s96 offen offset:2048 lds
  buffer_load_dwordx4 v243, s[16:19], s96 offen offset:3072 lds
  s_branch F_load
B_l_spare:
  s_mov_b32 s16, s76
  s_mov_b32 s17, s77
  s_mov_b32 s18, 5636096
  s_mov_b32 s19, 0x00020000
  s_mov_b32 s20, s68
  s_mov_b32 s21, s69
  s_mov_b32 s22, 524288
  s_mov_b32 s23, 0x00020000
  v_lshrrev_b32 v248, 3, v1
  s_lshl_b32 s28, s24, 5
  v_add_u32 v248, s28, v248
  v_bfe_u32 v249, v1, 4, 1
  v_lshlrev_b32 v249, 2, v249
  v_and_b32 v250, 7, v1
  v_xor_b32 v249, v249, v250
  v_lshlrev_b32 v249, 4, v249
  s_lshl_b32 s28, s29, 7
  v_mul_u32_u24 v240, 4096, v248
  v_add3_u32 v240, v240, v249, s28
  v_add_u32 v241, 31744, v240
  v_add_u32 v242, 63488, v240
  v_add_u32 v243, 95232, v240
  s_lshl_b32 s28, s30, 7
  v_mul_u32_u24 v244, 1024, v248
  v_add3_u32 v244, v244, v249, s28
  v_add_u32 v245, 7168, v244
  v_add_u32 v246, 14336, v244
  v_add_u32 v247, 21504, v244
  s_barrier
  s_barrier
  v_lshlrev_b32 v24, 7, v1
  s_lshl_b32 s87, s95, 2
  s_add_u32 s87, s87, s24
  s_lshl_b32 s90, s87, 14
  buffer_load_dword v30, v24, s[20:23], s90 offen
  s_add_u32 s90, s90, 8192
  buffer_load_dword v30, v24, s[20:23], s90 offen
  s_barrier
  s_lshl_b32 s28, s24, 12
  s_add_u32 m0, s28, 131072
  s_mul_i32 s96, s97, 524288
  buffer_load_dwordx4 v240, s[16:19], s96 offen offset:0 lds
  buffer_load_dwordx4 v241, s[16:19], s96 offen offset:1024 lds
  buffer_load_dwordx4 v242, s[16:19], s96 offen offset:2048 lds
  buffer_load_dwordx4 v243, s[16:19], s96 offen offset:3072 lds
  s_lshl_b32 s28, s24, 12
  s_add_u32 m0, s28, 147456
  s_add_u32 s96, s96, 524288
  s_cmp_eq_u32 s96, 5767168
  s_cselect_b32 s96, 0, s96
  buffer_load_dwordx4 v240, s[16:19], s96 offen offset:0 lds
  buffer_load_dwordx4 v241, s[16:19], s96 offen offset:1024 lds
  buffer_load_dwordx4 v242, s[16:19], s96 offen offset:2048 lds
  buffer_load_dwordx4 v243, s[16:19], s96 offen offset:3072 lds
  s_lshl_b32 s28, s24, 12
  s_add_u32 m0, s28, 0
  s_add_u32 s96, s96, 524288
  s_cmp_eq_u32 s96, 5767168
  s_cselect_b32 s96, 0, s96
  buffer_load_dwordx4 v240, s[16:19], s96 offen offset:0 lds
  buffer_load_dwordx4 v241, s[16:19], s96 offen offset:1024 lds
  buffer_load_dwordx4 v242, s[16:19], s96 offen offset:2048 lds
  buffer_load_dwordx4 v243, s[16:19], s96 offen offset:3072 lds
  s_lshl_b32 s28, s24, 12
  s_add_u32 m0, s28, 16384
  s_add_u32 s96, s96, 524288
  s_cmp_eq_u32 s96, 5767168
  s_cselect_b32 s96, 0, s96
  buffer_load_dwordx4 v240, s[16:19], s96 offen offset:0 lds
  buffer_load_dwordx4 v241, s[16:19], s96 offen offset:1024 lds
  buffer_load_dwordx4 v242, s[16:19], s96 offen offset:2048 lds
  buffer_load_dwordx4 v243, s[16:19], s96 offen offset:3072 lds
  s_branch F_load
B_cons:
  s_setprio 3
  s_lshl_b32 s28, s25, 9
  s_lshl_b32 s86, s26, 8
  s_add_u32 s28, s28, s86
  s_lshl_b32 s86, s27, 4
  s_add_u32 s91, s28, s86
  s_lshl_b32 s86, s24, 2
  v_lshrrev_b32 v10, 4, v1
  v_add_u32 v10, s86, v10
  v_and_b32 v11, 15, v1
  v_add_u32 v12, s91, v10
  v_lshlrev_b32 v13, 10, v12
  v_lshl_add_u32 v13, v11, 4, v13
  s_waitcnt lgkmcnt(0)
  s_mov_b32 s4, s64
  s_mov_b32 s5, s65
  s_mov_b32 s6, 2097152
  s_mov_b32 s7, 0x00020000
  buffer_load_dwordx4 v[32:35], v13, s[4:7], 0 offen offset:0
  buffer_load_dwordx4 v[36:39], v13, s[4:7], 0 offen offset:256
  buffer_load_dwordx4 v[40:43], v13, s[4:7], 0 offen offset:512
  buffer_load_dwordx4 v[44:47], v13, s[4:7], 0 offen offset:768
  v_mov_b32 v20, 163824
  v_mov_b32 v21, 0
  ds_write_b32 v20, v21
  s_waitcnt lgkmcnt(0)
  s_barrier
  s_mov_b32 s28, 10485760
  s_load_dword s31, s[84:85], s28
  s_mov_b32 s12, s84
  s_mov_b32 s13, s85
  s_mov_b32 s14, 10850304
  s_mov_b32 s15, 0x00020000
  v_lshlrev_b32 v14, 4, v12
  v_add_u32 v14, 10489856, v14
  v_mul_u32_u24 v15, 1088, v10
  v_lshl_add_u32 v15, v11, 4, v15
  v_add_u32 v15, 122880, v15
  v_bfe_u32 v16, v1, 2, 2
  v_lshrrev_b32 v17, 5, v1
  v_lshl_add_u32 v16, v17, 3, v16
  v_mul_u32_u24 v16, 1088, v16
  v_bfe_u32 v17, v1, 4, 1
  v_lshl_add_u32 v16, v17, 5, v16
  v_and_b32 v17, 3, v1
  v_lshl_add_u32 v16, v17, 3, v16
  s_lshl_b32 s28, s24, 8
  s_add_u32 s28, s28, 122880
  v_add_u32 v16, s28, v16
  s_lshl_b32 s28, s24, 19
  s_lshl_b32 s86, s91, 6
  s_add_u32 s28, s28, s86
  s_add_u32 s28, s28, 0
  v_lshl_add_u32 v17, v1, 4, s28
  s_lshl_b32 s28, s24, 14
  s_lshr_b32 s86, s91, 5
  s_lshl_b32 s86, s86, 7
  s_add_u32 s28, s28, s86
  s_and_b32 s86, s91, 16
  s_lshl_b32 s86, s86, 9
  s_add_u32 s28, s28, s86
  s_add_u32 s28, s28, 10522624
  v_mov_b32 v18, s28
  s_waitcnt lgkmcnt(0)
  s_add_u32 s31, s31, 1
  s_waitcnt vmcnt(0)
  v_lshlrev_b32 v48, 16, v32
  v_and_b32 v49, 0xffff0000, v32
  v_lshlrev_b32 v50, 16, v33
  v_and_b32 v51, 0xffff0000, v33
  v_lshlrev_b32 v52, 16, v34
  v_and_b32 v53, 0xffff0000, v34
  v_lshlrev_b32 v54, 16, v35
  v_and_b32 v55, 0xffff0000, v35
  v_lshlrev_b32 v56, 16, v36
  v_and_b32 v57, 0xffff0000, v36
  v_lshlrev_b32 v58, 16, v37
  v_and_b32 v59, 0xffff0000, v37
  v_lshlrev_b32 v60, 16, v38
  v_and_b32 v61, 0xffff0000, v38
  v_lshlrev_b32 v62, 16, v39
  v_and_b32 v63, 0xffff0000, v39
  v_lshlrev_b32 v64, 16, v40
  v_and_b32 v65, 0xffff0000, v40
  v_lshlrev_b32 v66, 16, v41
  v_and_b32 v67, 0xffff0000, v41
  v_lshlrev_b32 v68, 16, v42
  v_and_b32 v69, 0xffff0000, v42
  v_lshlrev_b32 v70, 16, v43
  v_and_b32 v71, 0xffff0000, v43
  v_lshlrev_b32 v72, 16, v44
  v_and_b32 v73, 0xffff0000, v44
  v_lshlrev_b32 v74, 16, v45
  v_and_b32 v75, 0xffff0000, v45
  v_lshlrev_b32 v76, 16, v46
  v_and_b32 v77, 0xffff0000, v46
  v_lshlrev_b32 v78, 16, v47
  v_and_b32 v79, 0xffff0000, v47
  v_pk_add_f32 v[80:81], v[48:49], v[50:51]
  v_pk_add_f32 v[82:83], v[52:53], v[54:55]
  v_pk_add_f32 v[84:85], v[56:57], v[58:59]
  v_pk_add_f32 v[86:87], v[60:61], v[62:63]
  v_pk_add_f32 v[80:81], v[80:81], v[64:65]
  v_pk_add_f32 v[82:83], v[82:83], v[66:67]
  v_pk_add_f32 v[84:85], v[84:85], v[68:69]
  v_pk_add_f32 v[86:87], v[86:87], v[70:71]
  v_pk_add_f32 v[80:81], v[80:81], v[72:73]
  v_pk_add_f32 v[82:83], v[82:83], v[74:75]
  v_pk_add_f32 v[84:85], v[84:85], v[76:77]
  v_pk_add_f32 v[86:87], v[86:87], v[78:79]
  v_pk_add_f32 v[80:81], v[80:81], v[82:83]
  v_pk_add_f32 v[84:85], v[84:85], v[86:87]
  v_pk_add_f32 v[80:81], v[80:81], v[84:85]
  v_add_f32 v80, v80, v81
  s_nop 1
  v_add_f32_dpp v80, v80, v80 quad_perm:[1,0,3,2] row_mask:0xf bank_mask:0xf
  s_nop 1
  v_add_f32_dpp v80, v80, v80 quad_perm:[2,3,0,1] row_mask:0xf bank_mask:0xf
  s_nop 1
  v_add_f32_dpp v80, v80, v80 row_half_mirror row_mask:0xf bank_mask:0xf
  s_nop 1
  v_add_f32_dpp v80, v80, v80 row_mirror row_mask:0xf bank_mask:0xf
  v_mul_f32 v88, 0xbb000000, v80
  v_pk_add_f32 v[48:49], v[48:49], v[88:89] op_sel_hi:[1,0]
  v_pk_add_f32 v[50:51], v[50:51], v[88:89] op_sel_hi:[1,0]
  v_pk_add_f32 v[52:53], v[52:53], v[88:89] op_sel_hi:[1,0]
  v_pk_add_f32 v[54:55], v[54:55], v[88:89] op_sel_hi:[1,0]
  v_pk_add_f32 v[56:57], v[56:57], v[88:89] op_sel_hi:[1,0]
  v_pk_add_f32 v[58:59], v[58:59], v[88:89] op_sel_hi:[1,0]
  v_pk_add_f32 v[60:61], v[60:61], v[88:89] op_sel_hi:[1,0]
  v_pk_add_f32 v[62:63], v[62:63], v[88:89] op_sel_hi:[1,0]
  v_pk_add_f32 v[64:65], v[64:65], v[88:89] op_sel_hi:[1,0]
  v_pk_add_f32 v[66:67], v[66:67], v[88:89] op_sel_hi:[1,0]
  v_pk_add_f32 v[68:69], v[68:69], v[88:89] op_sel_hi:[1,0]
  v_pk_add_f32 v[70:71], v[70:71], v[88:89] op_sel_hi:[1,0]
  v_pk_add_f32 v[72:73], v[72:73], v[88:89] op_sel_hi:[1,0]
  v_pk_add_f32 v[74:75], v[74:75], v[88:89] op_sel_hi:[1,0]
  v_pk_add_f32 v[76:77], v[76:77], v[88:89] op_sel_hi:[1,0]
  v_pk_add_f32 v[78:79], v[78:79], v[88:89] op_sel_hi:[1,0]
  v_pk_mul_f32 v[80:81], v[48:49], v[48:49]
  v_pk_mul_f32 v[82:83], v[50:51], v[50:51]
  v_pk_mul_f32 v[84:85], v[52:53], v[52:53]
  v_pk_mul_f32 v[86:87], v[54:55], v[54:55]
  v_pk_fma_f32 v[80:81], v[56:57], v[56:57], v[80:81]
  v_pk_fma_f32 v[82:83], v[58:59], v[58:59], v[82:83]
  v_pk_fma_f32 v[84:85], v[60:61], v[60:61], v[84:85]
  v_pk_fma_f32 v[86:87], v[62:63], v[62:63], v[86:87]
  v_pk_fma_f32 v[80:81], v[64:65], v[64:65], v[80:81]
  v_pk_fma_f32 v[82:83], v[66:67], v[66:67], v[82:83]
  v_pk_fma_f32 v[84:85], v[68:69], v[68:69], v[84:85]
  v_pk_fma_f32 v[86:87], v[70:71], v[70:71], v[86:87]
  v_pk_fma_f32 v[80:81], v[72:73], v[72:73], v[80:81]
  v_pk_fma_f32 v[82:83], v[74:75], v[74:75], v[82:83]
  v_pk_fma_f32 v[84:85], v[76:77], v[76:77], v[84:85]
  v_pk_fma_f32 v[86:87], v[78:79], v[78:79], v[86:87]
  v_pk_add_f32 v[80:81], v[80:81], v[82:83]
  v_pk_add_f32 v[84:85], v[84:85], v[86:87]
  v_pk_add_f32 v[80:81], v[80:81], v[84:85]
  v_add_f32 v80, v80, v81
  s_nop 1
  v_add_f32_dpp v80, v80, v80 quad_perm:[1,0,3,2] row_mask:0xf bank_mask:0xf
  s_nop 1
  v_add_f32_dpp v80, v80, v80 quad_perm:[2,3,0,1] row_mask:0xf bank_mask:0xf
  s_nop 1
  v_add_f32_dpp v80, v80, v80 row_half_mirror row_mask:0xf bank_mask:0xf
  s_nop 1
  v_add_f32_dpp v80, v80, v80 row_mirror row_mask:0xf bank_mask:0xf
  v_mov_b32 v81, 0x3727c5ac
  v_fmac_f32 v81, 0x3b000000, v80
  v_rsq_f32 v82, v81
  s_nop 0
  v_mov_b32 v90, v82
  v_mov_b32 v89, s31
  v_mov_b32 v91, s31
  s_mov_b32 exec_lo, 0x00010001
  s_mov_b32 exec_hi, 0x00010001
  buffer_store_dwordx4 v[88:91], v14, s[12:15], 0 offen sc1
  s_mov_b64 exec, -1
  v_pk_mul_f32 v[48:49], v[48:49], v[82:83] op_sel_hi:[1,0]
  v_pk_mul_f32 v[50:51], v[50:51], v[82:83] op_sel_hi:[1,0]
  v_pk_mul_f32 v[52:53], v[52:53], v[82:83] op_sel_hi:[1,0]
  v_pk_mul_f32 v[54:55], v[54:55], v[82:83] op_sel_hi:[1,0]
  v_pk_mul_f32 v[56:57], v[56:57], v[82:83] op_sel_hi:[1,0]
  v_pk_mul_f32 v[58:59], v[58:59], v[82:83] op_sel_hi:[1,0]
  v_pk_mul_f32 v[60:61], v[60:61], v[82:83] op_sel_hi:[1,0]
  v_pk_mul_f32 v[62:63], v[62:63], v[82:83] op_sel_hi:[1,0]
  v_pk_mul_f32 v[64:65], v[64:65], v[82:83] op_sel_hi:[1,0]
  v_pk_mul_f32 v[66:67], v[66:67], v[82:83] op_sel_hi:[1,0]
  v_pk_mul_f32 v[68:69], v[68:69], v[82:83] op_sel_hi:[1,0]
  v_pk_mul_f32 v[70:71], v[70:71], v[82:83] op_sel_hi:[1,0]
  v_pk_mul_f32 v[72:73], v[72:73], v[82:83] op_sel_hi:[1,0]
  v_pk_mul_f32 v[74:75], v[74:75], v[82:83] op_sel_hi:[1,0]
  v_pk_mul_f32 v[76:77], v[76:77], v[82:83] op_sel_hi:[1,0]
  v_pk_mul_f32 v[78:79], v[78:79], v[82:83] op_sel_hi:[1,0]
  v_cvt_pk_bf16_f32 v32, v48, v49
  v_cvt_pk_bf16_f32 v33, v50, v51
  v_cvt_pk_bf16_f32 v34, v52, v53
  v_cvt_pk_bf16_f32 v35, v54, v55
  v_cvt_pk_bf16_f32 v36, v56, v57
  v_cvt_pk_bf16_f32 v37, v58, v59
  v_cvt_pk_bf16_f32 v38, v60, v61
  v_cvt_pk_bf16_f32 v39, v62, v63
  v_cvt_pk_bf16_f32 v40, v64, v65
  v_cvt_pk_bf16_f32 v41, v66, v67
  v_cvt_pk_bf16_f32 v42, v68, v69
  v_cvt_pk_bf16_f32 v43, v70, v71
  v_cvt_pk_bf16_f32 v44, v72, v73
  v_cvt_pk_bf16_f32 v45, v74, v75
  v_cvt_pk_bf16_f32 v46, v76, v77
  v_cvt_pk_bf16_f32 v47, v78, v79
  v_lshlrev_b32 v48, 16, v32
  v_and_b32 v49, 0xffff0000, v32
  v_lshlrev_b32 v50, 16, v33
  v_and_b32 v51, 0xffff0000, v33
  v_lshlrev_b32 v52, 16, v34
  v_and_b32 v53, 0xffff0000, v34
  v_lshlrev_b32 v54, 16, v35
  v_and_b32 v55, 0xffff0000, v35
  v_lshlrev_b32 v56, 16, v36
  v_and_b32 v57, 0xffff0000, v36
  v_lshlrev_b32 v58, 16, v37
  v_and_b32 v59, 0xffff0000, v37
  v_lshlrev_b32 v60, 16, v38
  v_and_b32 v61, 0xffff0000, v38
  v_lshlrev_b32 v62, 16, v39
  v_and_b32 v63, 0xffff0000, v39
  v_lshlrev_b32 v64, 16, v40
  v_and_b32 v65, 0xffff0000, v40
  v_lshlrev_b32 v66, 16, v41
  v_and_b32 v67, 0xffff0000, v41
  v_lshlrev_b32 v68, 16, v42
  v_and_b32 v69, 0xffff0000, v42
  v_lshlrev_b32 v70, 16, v43
  v_and_b32 v71, 0xffff0000, v43
  v_lshlrev_b32 v72, 16, v44
  v_and_b32 v73, 0xffff0000, v44
  v_lshlrev_b32 v74, 16, v45
  v_and_b32 v75, 0xffff0000, v45
  v_lshlrev_b32 v76, 16, v46
  v_and_b32 v77, 0xffff0000, v46
  v_lshlrev_b32 v78, 16, v47
  v_and_b32 v79, 0xffff0000, v47
  v_pk_add_f32 v[80:81], v[48:49], v[50:51]
  v_pk_add_f32 v[82:83], v[52:53], v[54:55]
  v_pk_add_f32 v[84:85], v[56:57], v[58:59]
  v_pk_add_f32 v[86:87], v[60:61], v[62:63]
  v_pk_add_f32 v[80:81], v[80:81], v[64:65]
  v_pk_add_f32 v[82:83], v[82:83], v[66:67]
  v_pk_add_f32 v[84:85], v[84:85], v[68:69]
  v_pk_add_f32 v[86:87], v[86:87], v[70:71]
  v_pk_add_f32 v[80:81], v[80:81], v[72:73]
  v_pk_add_f32 v[82:83], v[82:83], v[74:75]
  v_pk_add_f32 v[84:85], v[84:85], v[76:77]
  v_pk_add_f32 v[86:87], v[86:87], v[78:79]
  v_pk_add_f32 v[80:81], v[80:81], v[82:83]
  v_pk_add_f32 v[84:85], v[84:85], v[86:87]
  v_pk_add_f32 v[80:81], v[80:81], v[84:85]
  v_add_f32 v80, v80, v81
  s_nop 1
  v_add_f32_dpp v80, v80, v80 quad_perm:[1,0,3,2] row_mask:0xf bank_mask:0xf
  s_nop 1
  v_add_f32_dpp v80, v80, v80 quad_perm:[2,3,0,1] row_mask:0xf bank_mask:0xf
  s_nop 1
  v_add_f32_dpp v80, v80, v80 row_half_mirror row_mask:0xf bank_mask:0xf
  s_nop 1
  v_add_f32_dpp v80, v80, v80 row_mirror row_mask:0xf bank_mask:0xf
  v_mul_f32 v88, 0xbb000000, v80
  v_pk_add_f32 v[48:49], v[48:49], v[88:89] op_sel_hi:[1,0]
  v_pk_add_f32 v[50:51], v[50:51], v[88:89] op_sel_hi:[1,0]
  v_pk_add_f32 v[52:53], v[52:53], v[88:89] op_sel_hi:[1,0]
  v_pk_add_f32 v[54:55], v[54:55], v[88:89] op_sel_hi:[1,0]
  v_pk_add_f32 v[56:57], v[56:57], v[88:89] op_sel_hi:[1,0]
  v_pk_add_f32 v[58:59], v[58:59], v[88:89] op_sel_hi:[1,0]
  v_pk_add_f32 v[60:61], v[60:61], v[88:89] op_sel_hi:[1,0]
  v_pk_add_f32 v[62:63], v[62:63], v[88:89] op_sel_hi:[1,0]
  v_pk_add_f32 v[64:65], v[64:65], v[88:89] op_sel_hi:[1,0]
  v_pk_add_f32 v[66:67], v[66:67], v[88:89] op_sel_hi:[1,0]
  v_pk_add_f32 v[68:69], v[68:69], v[88:89] op_sel_hi:[1,0]
  v_pk_add_f32 v[70:71], v[70:71], v[88:89] op_sel_hi:[1,0]
  v_pk_add_f32 v[72:73], v[72:73], v[88:89] op_sel_hi:[1,0]
  v_pk_add_f32 v[74:75], v[74:75], v[88:89] op_sel_hi:[1,0]
  v_pk_add_f32 v[76:77], v[76:77], v[88:89] op_sel_hi:[1,0]
  v_pk_add_f32 v[78:79], v[78:79], v[88:89] op_sel_hi:[1,0]
  v_pk_mul_f32 v[80:81], v[48:49], v[48:49]
  v_pk_mul_f32 v[82:83], v[50:51], v[50:51]
  v_pk_mul_f32 v[84:85], v[52:53], v[52:53]
  v_pk_mul_f32 v[86:87], v[54:55], v[54:55]
  v_pk_fma_f32 v[80:81], v[56:57], v[56:57], v[80:81]
  v_pk_fma_f32 v[82:83], v[58:59], v[58:59], v[82:83]
  v_pk_fma_f32 v[84:85], v[60:61], v[60:61], v[84:85]
  v_pk_fma_f32 v[86:87], v[62:63], v[62:63], v[86:87]
  v_pk_fma_f32 v[80:81], v[64:65], v[64:65], v[80:81]
  v_pk_fma_f32 v[82:83], v[66:67], v[66:67], v[82:83]
  v_pk_fma_f32 v[84:85], v[68:69], v[68:69], v[84:85]
  v_pk_fma_f32 v[86:87], v[70:71], v[70:71], v[86:87]
  v_pk_fma_f32 v[80:81], v[72:73], v[72:73], v[80:81]
  v_pk_fma_f32 v[82:83], v[74:75], v[74:75], v[82:83]
  v_pk_fma_f32 v[84:85], v[76:77], v[76:77], v[84:85]
  v_pk_fma_f32 v[86:87], v[78:79], v[78:79], v[86:87]
  v_pk_add_f32 v[80:81], v[80:81], v[82:83]
  v_pk_add_f32 v[84:85], v[84:85], v[86:87]
  v_pk_add_f32 v[80:81], v[80:81], v[84:85]
  v_add_f32 v80, v80, v81
  s_nop 1
  v_add_f32_dpp v80, v80, v80 quad_perm:[1,0,3,2] row_mask:0xf bank_mask:0xf
  s_nop 1
  v_add_f32_dpp v80, v80, v80 quad_perm:[2,3,0,1] row_mask:0xf bank_mask:0xf
  s_nop 1
  v_add_f32_dpp v80, v80, v80 row_half_mirror row_mask:0xf bank_mask:0xf
  s_nop 1
  v_add_f32_dpp v80, v80, v80 row_mirror row_mask:0xf bank_mask:0xf
  v_mov_b32 v81, 0x3727c5ac
  v_fmac_f32 v81, 0x3b000000, v80
  v_rsq_f32 v82, v81
  s_nop 0
  v_pk_mul_f32 v[48:49], v[48:49], v[82:83] op_sel_hi:[1,0]
  v_pk_mul_f32 v[50:51], v[50:51], v[82:83] op_sel_hi:[1,0]
  v_pk_mul_f32 v[52:53], v[52:53], v[82:83] op_sel_hi:[1,0]
  v_pk_mul_f32 v[54:55], v[54:55], v[82:83] op_sel_hi:[1,0]
  v_pk_mul_f32 v[56:57], v[56:57], v[82:83] op_sel_hi:[1,0]
  v_pk_mul_f32 v[58:59], v[58:59], v[82:83] op_sel_hi:[1,0]
  v_pk_mul_f32 v[60:61], v[60:61], v[82:83] op_sel_hi:[1,0]
  v_pk_mul_f32 v[62:63], v[62:63], v[82:83] op_sel_hi:[1,0]
  v_pk_mul_f32 v[64:65], v[64:65], v[82:83] op_sel_hi:[1,0]
  v_pk_mul_f32 v[66:67], v[66:67], v[82:83] op_sel_hi:[1,0]
  v_pk_mul_f32 v[68:69], v[68:69], v[82:83] op_sel_hi:[1,0]
  v_pk_mul_f32 v[70:71], v[70:71], v[82:83] op_sel_hi:[1,0]
  v_pk_mul_f32 v[72:73], v[72:73], v[82:83] op_sel_hi:[1,0]
  v_pk_mul_f32 v[74:75], v[74:75], v[82:83] op_sel_hi:[1,0]
  v_pk_mul_f32 v[76:77], v[76:77], v[82:83] op_sel_hi:[1,0]
  v_pk_mul_f32 v[78:79], v[78:79], v[82:83] op_sel_hi:[1,0]
  v_cvt_pk_bf16_f32 v32, v48, v49
  v_cvt_pk_bf16_f32 v33, v50, v51
  v_cvt_pk_bf16_f32 v34, v52, v53
  v_cvt_pk_bf16_f32 v35, v54, v55
  v_cvt_pk_bf16_f32 v36, v56, v57
  v_cvt_pk_bf16_f32 v37, v58, v59
  v_cvt_pk_bf16_f32 v38, v60, v61
  v_cvt_pk_bf16_f32 v39, v62, v63
  v_cvt_pk_bf16_f32 v40, v64, v65
  v_cvt_pk_bf16_f32 v41, v66, v67
  v_cvt_pk_bf16_f32 v42, v68, v69
  v_cvt_pk_bf16_f32 v43, v70, v71
  v_cvt_pk_bf16_f32 v44, v72, v73
  v_cvt_pk_bf16_f32 v45, v74, v75
  v_cvt_pk_bf16_f32 v46, v76, v77
  v_cvt_pk_bf16_f32 v47, v78, v79
  ds_write_b128 v15, v[32:35] offset:0
  ds_write_b128 v15, v[36:39] offset:256
  ds_write_b128 v15, v[40:43] offset:512
  ds_write_b128 v15, v[44:47] offset:768
  v_mov_b32 v21, 1
  s_waitcnt lgkmcnt(0)
  s_mov_b64 exec, 1
  ds_add_u32 v20, v21
  s_mov_b64 exec, -1
  s_mov_b32 s93, 0
B_lnsync:
  ds_read_b32 v21, v20
  s_add_u32 s93, s93, 1
  s_waitcnt lgkmcnt(0)
  v_readfirstlane_b32 s28, v21
  s_cmp_ge_u32 s93, 100000
  s_cbranch_scc1 B_lnsync_ok
  s_nop 1
  s_cmp_lt_u32 s28, 4
  s_cbranch_scc1 B_lnsync
B_lnsync_ok:
  ds_read_b64_tr_b16 v[48:49], v16 offset:0
  ds_read_b64_tr_b16 v[50:51], v16 offset:4352
  ds_read_b64_tr_b16 v[52:53], v16 offset:64
  ds_read_b64_tr_b16 v[54:55], v16 offset:4416
  ds_read_b64_tr_b16 v[56:57], v16 offset:128
  ds_read_b64_tr_b16 v[58:59], v16 offset:4480
  ds_read_b64_tr_b16 v[60:61], v16 offset:192
  ds_read_b64_tr_b16 v[62:63], v16 offset:4544
  v_mov_b32 v19, s31
  s_mov_b32 s28, 0
  s_waitcnt lgkmcnt(6)
  buffer_store_dwordx4 v[48:51], v17, s[12:15], s28 offen sc1
  s_mov_b32 s28, 131072
  s_waitcnt lgkmcnt(4)
  buffer_store_dwordx4 v[52:55], v17, s[12:15], s28 offen sc1
  s_mov_b32 s28, 262144
  s_waitcnt lgkmcnt(2)
  buffer_store_dwordx4 v[56:59], v17, s[12:15], s28 offen sc1
  s_mov_b32 s28, 393216
  s_waitcnt lgkmcnt(0)
  buffer_store_dwordx4 v[60:63], v17, s[12:15], s28 offen sc1
  s_waitcnt vmcnt(0)
  s_mov_b64 exec, 1
  buffer_store_dword v19, v18, s[12:15], 0 offen sc1
  s_mov_b64 exec, -1
  s_barrier
  s_cmp_eq_u32 s94, 15
  s_cbranch_scc1 F_cons
  s_and_b32 s91, s24, 1
  s_lshr_b32 s92, s24, 1
  v_lshrrev_b32 v15, 5, v1
  s_mul_i32 s28, s94, 192
  s_lshl_b32 s86, s91, 7
  s_add_u32 s86, s86, s28
  v_lshl_add_u32 v12, v15, 3, s86
  s_lshl_b32 s86, s91, 5
  s_add_u32 s86, s86, s28
  s_add_u32 s86, s86, 64
  v_lshl_add_u32 v13, v15, 3, s86
  s_mov_b32 s8, s74
  s_mov_b32 s9, s75
  s_mov_b32 s10, 2752
  s_mov_b32 s11, 0x00020000
  buffer_load_dwordx2 v[180:181], v12, s[8:11], 0 offen offset:0
  buffer_load_dwordx2 v[182:183], v12, s[8:11], 0 offen offset:16
  buffer_load_dwordx2 v[184:185], v12, s[8:11], 0 offen offset:32
  buffer_load_dwordx2 v[186:187], v12, s[8:11], 0 offen offset:48
  buffer_load_dwordx2 v[188:189], v13, s[8:11], 0 offen offset:0
  buffer_load_dwordx2 v[190:191], v13, s[8:11], 0 offen offset:16
  s_lshr_b32 s28, s95, 1
  s_lshl_b32 s28, s28, 14
  s_add_u32 s28, s28, 10522624
  s_lshl_b32 s86, s91, 13
  s_add_u32 s28, s28, s86
  v_lshl_add_u32 v12, v1, 7, s28
  s_lshl_b32 s86, s98, 9
  s_add_u32 s88, s28, s86
  s_lshl_b32 s28, s95, 1
  s_add_u32 s28, s28, s92
  s_lshl_b32 s28, s28, 17
  s_lshl_b32 s86, s91, 10
  s_add_u32 s28, s28, s86
  s_add_u32 s28, s28, 0
  v_lshl_add_u32 v11, v1, 4, s28
  v_bfe_u32 v13, v1, 2, 2
  v_lshl_add_u32 v13, v15, 3, v13
  v_mul_u32_u24 v13, 192, v13
  v_bfe_u32 v14, v1, 4, 1
  v_lshl_add_u32 v13, v14, 5, v13
  v_and_b32 v14, 3, v1
  v_lshl_add_u32 v13, v14, 3, v13
  s_mul_i32 s28, s91, 3072
  s_add_u32 s86, s28, 64
  v_add_u32 v5, s86, v13
  s_lshl_b32 s86, s91, 7
  s_add_u32 s87, s28, s86
  v_add_u32 v2, s87, v13
  s_sub_u32 s87, s28, s86
  s_add_u32 s87, s87, 128
  v_add_u32 v8, s87, v13
  v_add_u32 v3, 0x10000, v2
  v_add_u32 v4, 0x20000, v2
  v_add_u32 v6, 0x10000, v5
  v_add_u32 v7, 0x20000, v5
  v_add_u32 v9, 0x10000, v8
  v_add_u32 v10, 0x20000, v8
  s_mov_b32 s93, 0
B_pollh:
  s_sleep 6
  buffer_load_dword v14, v12, s[12:15], 0 offen sc1
  s_add_u32 s93, s93, 1
  s_waitcnt vmcnt(0)
  v_cmp_ne_u32 vcc, s31, v14
  s_cmp_ge_u32 s93, 100000
  s_cbranch_scc1 B_pollh_ok
  s_nop 1
  s_cbranch_vccz B_pollh_ok
  s_branch B_pollh
B_pollh_ok:
  s_mov_b64 exec, -1
  s_add_u32 s90, s98, 0
  s_and_b32 s90, s90, 7
  s_add_u32 s90, s90, 0
  s_lshl_b32 s90, s90, 13
  buffer_load_dwordx4 v[100:103], v11, s[12:15], s90 offen offset:0 sc1
  buffer_load_dwordx4 v[104:107], v11, s[12:15], s90 offen offset:2048 sc1
  s_add_u32 s90, s90, 4096
  buffer_load_dwordx4 v[108:111], v11, s[12:15], s90 offen offset:0 sc1
  buffer_load_dwordx4 v[112:115], v11, s[12:15], s90 offen offset:2048 sc1
  s_add_u32 s90, s98, 1
  s_and_b32 s90, s90, 7
  s_add_u32 s90, s90, 0
  s_lshl_b32 s90, s90, 13
  buffer_load_dwordx4 v[116:119], v11, s[12:15], s90 offen offset:0 sc1
  buffer_load_dwordx4 v[120:123], v11, s[12:15], s90 offen offset:2048 sc1
  s_add_u32 s90, s90, 4096
  buffer_load_dwordx4 v[124:127], v11, s[12:15], s90 offen offset:0 sc1
  buffer_load_dwordx4 v[128:131], v11, s[12:15], s90 offen offset:2048 sc1
  s_add_u32 s90, s98, 2
  s_and_b32 s90, s90, 7
  s_add_u32 s90, s90, 0
  s_lshl_b32 s90, s90, 13
  buffer_load_dwordx4 v[132:135], v11, s[12:15], s90 offen offset:0 sc1
  buffer_load_dwordx4 v[136:139], v11, s[12:15], s90 offen offset:2048 sc1
  s_waitcnt vmcnt(10)
  v_lshlrev_b32 v16, 16, v180
  v_and_b32 v17, 0xffff0000, v180
  v_lshlrev_b32 v18, 16, v181
  v_and_b32 v19, 0xffff0000, v181
  v_lshlrev_b32 v20, 16, v182
  v_and_b32 v21, 0xffff0000, v182
  v_lshlrev_b32 v22, 16, v183
  v_and_b32 v23, 0xffff0000, v183
  v_lshlrev_b32 v24, 16, v184
  v_and_b32 v25, 0xffff0000, v184
  v_lshlrev_b32 v26, 16, v185
  v_and_b32 v27, 0xffff0000, v185
  v_lshlrev_b32 v28, 16, v186
  v_and_b32 v29, 0xffff0000, v186
  v_lshlrev_b32 v30, 16, v187
  v_and_b32 v31, 0xffff0000, v187
  s_barrier
  ds_read_b64_tr_b16 v[64:65], v2 offset:0
  ds_read_b64_tr_b16 v[66:67], v2 offset:768
  ds_read_b64_tr_b16 v[68:69], v5 offset:0
  ds_read_b64_tr_b16 v[70:71], v5 offset:768
  ds_read_b64_tr_b16 v[72:73], v8 offset:0
  ds_read_b64_tr_b16 v[74:75], v8 offset:768
  ds_read_b64_tr_b16 v[76:77], v2 offset:6144
  ds_read_b64_tr_b16 v[78:79], v2 offset:6912
  ds_read_b64_tr_b16 v[80:81], v5 offset:6144
  ds_read_b64_tr_b16 v[82:83], v5 offset:6912
  ds_read_b64_tr_b16 v[84:85], v8 offset:6144
  ds_read_b64_tr_b16 v[86:87], v8 offset:6912
  s_waitcnt lgkmcnt(6)
  s_waitcnt vmcnt(9)
  v_mfma_f32_32x32x16_bf16 v[16:31], v[64:67], v[100:103], v[16:31]
  ds_read_b64_tr_b16 v[88:89], v2 offset:12288
  ds_read_b64_tr_b16 v[90:91], v2 offset:13056
  ds_read_b64_tr_b16 v[92:93], v5 offset:12288
  v_mfma_f32_32x32x16_bf16 v[32:47], v[68:71], v[100:103], 0
  ds_read_b64_tr_b16 v[94:95], v5 offset:13056
  ds_read_b64_tr_b16 v[96:97], v8 offset:12288
  ds_read_b64_tr_b16 v[98:99], v8 offset:13056
  v_mfma_f32_32x32x16_bf16 v[48:63], v[72:75], v[100:103], 0
  s_add_u32 s90, s90, 4096
  buffer_load_dwordx4 v[100:103], v11, s[12:15], s90 offen offset:0 sc1
  s_waitcnt lgkmcnt(6)
  s_waitcnt vmcnt(9)
  v_mfma_f32_32x32x16_bf16 v[16:31], v[76:79], v[104:107], v[16:31]
  ds_read_b64_tr_b16 v[64:65], v2 offset:18432
  ds_read_b64_tr_b16 v[66:67], v2 offset:19200
  ds_read_b64_tr_b16 v[68:69], v5 offset:18432
  v_mfma_f32_32x32x16_bf16 v[32:47], v[80:83], v[104:107], v[32:47]
  ds_read_b64_tr_b16 v[70:71], v5 offset:19200
  ds_read_b64_tr_b16 v[72:73], v8 offset:18432
  ds_read_b64_tr_b16 v[74:75], v8 offset:19200
  v_mfma_f32_32x32x16_bf16 v[48:63], v[84:87], v[104:107], v[48:63]
  buffer_load_dwordx4 v[104:107], v11, s[12:15], s90 offen offset:2048 sc1
  s_waitcnt lgkmcnt(6)
  s_waitcnt vmcnt(9)
  v_mfma_f32_32x32x16_bf16 v[16:31], v[88:91], v[108:111], v[16:31]
  s_waitcnt lgkmcnt(0)
  s_barrier
  ds_read_b64_tr_b16 v[76:77], v2 offset:24576
  ds_read_b64_tr_b16 v[78:79], v2 offset:25344
  ds_read_b64_tr_b16 v[80:81], v5 offset:24576
  v_mfma_f32_32x32x16_bf16 v[32:47], v[92:95], v[108:111], v[32:47]
  ds_read_b64_tr_b16 v[82:83], v5 offset:25344
  ds_read_b64_tr_b16 v[84:85], v8 offset:24576
  ds_read_b64_tr_b16 v[86:87], v8 offset:25344
  v_mfma_f32_32x32x16_bf16 v[48:63], v[96:99], v[108:111], v[48:63]
  s_add_u32 s90, s98, 3
  s_and_b32 s90, s90, 7
  s_add_u32 s90, s90, 0
  s_lshl_b32 s90, s90, 13
  buffer_load_dwordx4 v[108:111], v11, s[12:15], s90 offen offset:0 sc1
  s_waitcnt lgkmcnt(6)
  s_waitcnt vmcnt(9)
  v_mfma_f32_32x32x16_bf16 v[16:31], v[64:67], v[112:115], v[16:31]
  ds_read_b64_tr_b16 v[88:89], v2 offset:30720
  ds_read_b64_tr_b16 v[90:91], v2 offset:31488
  ds_read_b64_tr_b16 v[92:93], v5 offset:30720
  v_mfma_f32_32x32x16_bf16 v[32:47], v[68:71], v[112:115], v[32:47]
  ds_read_b64_tr_b16 v[94:95], v5 offset:31488
  ds_read_b64_tr_b16 v[96:97], v8 offset:30720
  ds_read_b64_tr_b16 v[98:99], v8 offset:31488
  v_mfma_f32_32x32x16_bf16 v[48:63], v[72:75], v[112:115], v[48:63]
  buffer_load_dwordx4 v[112:115], v11, s[12:15], s90 offen offset:2048 sc1
  s_waitcnt lgkmcnt(6)
  s_waitcnt vmcnt(9)
  v_mfma_f32_32x32x16_bf16 v[16:31], v[76:79], v[116:119], v[16:31]
  ds_read_b64_tr_b16 v[64:65], v2 offset:36864
  ds_read_b64_tr_b16 v[66:67], v2 offset:37632
  ds_read_b64_tr_b16 v[68:69], v5 offset:36864
  v_mfma_f32_32x32x16_bf16 v[32:47], v[80:83], v[116:119], v[32:47]
  ds_read_b64_tr_b16 v[70:71], v5 offset:37632
  ds_read_b64_tr_b16 v[72:73], v8 offset:36864
  ds_read_b64_tr_b16 v[74:75], v8 offset:37632
  v_mfma_f32_32x32x16_bf16 v[48:63], v[84:87], v[116:119], v[48:63]
  s_add_u32 s90, s90, 4096
  buffer_load_dwordx4 v[116:119], v11, s[12:15], s90 offen offset:0 sc1
  s_waitcnt lgkmcnt(6)
  s_waitcnt vmcnt(9)
  v_mfma_f32_32x32x16_bf16 v[16:31], v[88:91], v[120:123], v[16:31]
  ds_read_b64_tr_b16 v[76:77], v2 offset:43008
  ds_read_b64_tr_b16 v[78:79], v2 offset:43776
  ds_read_b64_tr_b16 v[80:81], v5 offset:43008
  v_mfma_f32_32x32x16_bf16 v[32:47], v[92:95], v[120:123], v[32:47]
  ds_read_b64_tr_b16 v[82:83], v5 offset:43776
  ds_read_b64_tr_b16 v[84:85], v8 offset:43008
  ds_read_b64_tr_b16 v[86:87], v8 offset:43776
  v_mfma_f32_32x32x16_bf16 v[48:63], v[96:99], v[120:123], v[48:63]
  buffer_load_dwordx4 v[120:123], v11, s[12:15], s90 offen offset:2048 sc1
  s_waitcnt lgkmcnt(6)
  s_waitcnt vmcnt(9)
  v_mfma_f32_32x32x16_bf16 v[16:31], v[64:67], v[124:127], v[16:31]
  s_waitcnt lgkmcnt(0)
  s_barrier
  ds_read_b64_tr_b16 v[88:89], v2 offset:49152
  ds_read_b64_tr_b16 v[90:91], v2 offset:49920
  ds_read_b64_tr_b16 v[92:93], v5 offset:49152
  v_mfma_f32_32x32x16_bf16 v[32:47], v[68:71], v[124:127], v[32:47]
  ds_read_b64_tr_b16 v[94:95], v5 offset:49920
  ds_read_b64_tr_b16 v[96:97], v8 offset:49152
  ds_read_b64_tr_b16 v[98:99], v8 offset:49920
  v_mfma_f32_32x32x16_bf16 v[48:63], v[72:75], v[124:127], v[48:63]
  s_add_u32 s90, s98, 4
  s_and_b32 s90, s90, 7
  s_add_u32 s90, s90, 0
  s_lshl_b32 s90, s90, 13
  buffer_load_dwordx4 v[124:127], v11, s[12:15], s90 offen offset:0 sc1
  s_waitcnt lgkmcnt(6)
  s_waitcnt vmcnt(9)
  v_mfma_f32_32x32x16_bf16 v[16:31], v[76:79], v[128:131], v[16:31]
  ds_read_b64_tr_b16 v[64:65], v2 offset:55296
  ds_read_b64_tr_b16 v[66:67], v2 offset:56064
  ds_read_b64_tr_b16 v[68:69], v5 offset:55296
  v_mfma_f32_32x32x16_bf16 v[32:47], v[80:83], v[128:131], v[32:47]
  ds_read_b64_tr_b16 v[70:71], v5 offset:56064
  ds_read_b64_tr_b16 v[72:73], v8 offset:55296
  ds_read_b64_tr_b16 v[74:75], v8 offset:56064
  v_mfma_f32_32x32x16_bf16 v[48:63], v[84:87], v[128:131], v[48:63]
  buffer_load_dwordx4 v[128:131], v11, s[12:15], s90 offen offset:2048 sc1
  s_waitcnt lgkmcnt(6)
  s_waitcnt vmcnt(9)
  v_mfma_f32_32x32x16_bf16 v[16:31], v[88:91], v[132:135], v[16:31]
  ds_read_b64_tr_b16 v[76:77], v2 offset:61440
  ds_read_b64_tr_b16 v[78:79], v2 offset:62208
  ds_read_b64_tr_b16 v[80:81], v5 offset:61440
  v_mfma_f32_32x32x16_bf16 v[32:47], v[92:95], v[132:135], v[32:47]
  ds_read_b64_tr_b16 v[82:83], v5 offset:62208
  ds_read_b64_tr_b16 v[84:85], v8 offset:61440
  ds_read_b64_tr_b16 v[86:87], v8 offset:62208
  v_mfma_f32_32x32x16_bf16 v[48:63], v[96:99], v[132:135], v[48:63]
  s_add_u32 s90, s90, 4096
  buffer_load_dwordx4 v[132:135], v11, s[12:15], s90 offen offset:0 sc1
  s_waitcnt lgkmcnt(6)
  s_waitcnt vmcnt(9)
  v_mfma_f32_32x32x16_bf16 v[16:31], v[64:67], v[136:139], v[16:31]
  ds_read_b64_tr_b16 v[88:89], v3 offset:2048
  ds_read_b64_tr_b16 v[90:91], v3 offset:2816
  ds_read_b64_tr_b16 v[92:93], v6 offset:2048
  v_mfma_f32_32x32x16_bf16 v[32:47], v[68:71], v[136:139], v[32:47]
  ds_read_b64_tr_b16 v[94:95], v6 offset:2816
  ds_read_b64_tr_b16 v[96:97], v9 offset:2048
  ds_read_b64_tr_b16 v[98:99], v9 offset:2816
  v_mfma_f32_32x32x16_bf16 v[48:63], v[72:75], v[136:139], v[48:63]
  buffer_load_dwordx4 v[136:139], v11, s[12:15], s90 offen offset:2048 sc1
  s_waitcnt lgkmcnt(6)
  s_waitcnt vmcnt(9)
  v_mfma_f32_32x32x16_bf16 v[16:31], v[76:79], v[100:103], v[16:31]
  s_waitcnt lgkmcnt(0)
  s_barrier
  ds_read_b64_tr_b16 v[64:65], v3 offset:8192
  ds_read_b64_tr_b16 v[66:67], v3 offset:8960
  ds_read_b64_tr_b16 v[68:69], v6 offset:8192
  v_mfma_f32_32x32x16_bf16 v[32:47], v[80:83], v[100:103], v[32:47]
  ds_read_b64_tr_b16 v[70:71], v6 offset:8960
  ds_read_b64_tr_b16 v[72:73], v9 offset:8192
  ds_read_b64_tr_b16 v[74:75], v9 offset:8960
  v_mfma_f32_32x32x16_bf16 v[48:63], v[84:87], v[100:103], v[48:63]
  s_add_u32 s90, s98, 5
  s_and_b32 s90, s90, 7
  s_add_u32 s90, s90, 0
  s_lshl_b32 s90, s90, 13
  buffer_load_dwordx4 v[100:103], v11, s[12:15], s90 offen offset:0 sc1
  s_waitcnt lgkmcnt(6)
  s_waitcnt vmcnt(9)
  v_mfma_f32_32x32x16_bf16 v[16:31], v[88:91], v[104:107], v[16:31]
  ds_read_b64_tr_b16 v[76:77], v3 offset:14336
  ds_read_b64_tr_b16 v[78:79], v3 offset:15104
  ds_read_b64_tr_b16 v[80:81], v6 offset:14336
  v_mfma_f32_32x32x16_bf16 v[32:47], v[92:95], v[104:107], v[32:47]
  ds_read_b64_tr_b16 v[82:83], v6 offset:15104
  ds_read_b64_tr_b16 v[84:85], v9 offset:14336
  ds_read_b64_tr_b16 v[86:87], v9 offset:15104
  v_mfma_f32_32x32x16_bf16 v[48:63], v[96:99], v[104:107], v[48:63]
  buffer_load_dwordx4 v[104:107], v11, s[12:15], s90 offen offset:2048 sc1
  s_waitcnt lgkmcnt(6)
  s_waitcnt vmcnt(9)
  v_mfma_f32_32x32x16_bf16 v[16:31], v[64:67], v[108:111], v[16:31]
  ds_read_b64_tr_b16 v[88:89], v3 offset:20480
  ds_read_b64_tr_b16 v[90:91], v3 offset:21248
  ds_read_b64_tr_b16 v[92:93], v6 offset:20480
  v_mfma_f32_32x32x16_bf16 v[32:47], v[68:71], v[108:111], v[32:47]
  ds_read_b64_tr_b16 v[94:95], v6 offset:21248
  ds_read_b64_tr_b16 v[96:97], v9 offset:20480
  ds_read_b64_tr_b16 v[98:99], v9 offset:21248
  v_mfma_f32_32x32x16_bf16 v[48:63], v[72:75], v[108:111], v[48:63]
  s_add_u32 s90, s90, 4096
  buffer_load_dwordx4 v[108:111], v11, s[12:15], s90 offen offset:0 sc1
  s_waitcnt lgkmcnt(6)
  s_waitcnt vmcnt(9)
  v_mfma_f32_32x32x16_bf16 v[16:31], v[76:79], v[112:115], v[16:31]
  ds_read_b64_tr_b16 v[64:65], v3 offset:26624
  ds_read_b64_tr_b16 v[66:67], v3 offset:27392
  ds_read_b64_tr_b16 v[68:69], v6 offset:26624
  v_mfma_f32_32x32x16_bf16 v[32:47], v[80:83], v[112:115], v[32:47]
  ds_read_b64_tr_b16 v[70:71], v6 offset:27392
  ds_read_b64_tr_b16 v[72:73], v9 offset:26624
  ds_read_b64_tr_b16 v[74:75], v9 offset:27392
  v_mfma_f32_32x32x16_bf16 v[48:63], v[84:87], v[112:115], v[48:63]
  buffer_load_dwordx4 v[112:115], v11, s[12:15], s90 offen offset:2048 sc1
  s_waitcnt lgkmcnt(6)
  s_waitcnt vmcnt(9)
  v_mfma_f32_32x32x16_bf16 v[16:31], v[88:91], v[116:119], v[16:31]
  s_waitcnt lgkmcnt(0)
  s_barrier
  ds_read_b64_tr_b16 v[76:77], v3 offset:32768
  ds_read_b64_tr_b16 v[78:79], v3 offset:33536
  ds_read_b64_tr_b16 v[80:81], v6 offset:32768
  v_mfma_f32_32x32x16_bf16 v[32:47], v[92:95], v[116:119], v[32:47]
  ds_read_b64_tr_b16 v[82:83], v6 offset:33536
  ds_read_b64_tr_b16 v[84:85], v9 offset:32768
  ds_read_b64_tr_b16 v[86:87], v9 offset:33536
  v_mfma_f32_32x32x16_bf16 v[48:63], v[96:99], v[116:119], v[48:63]
  s_add_u32 s90, s98, 6
  s_and_b32 s90, s90, 7
  s_add_u32 s90, s90, 0
  s_lshl_b32 s90, s90, 13
  buffer_load_dwordx4 v[116:119], v11, s[12:15], s90 offen offset:0 sc1
  s_waitcnt lgkmcnt(6)
  s_waitcnt vmcnt(9)
  v_mfma_f32_32x32x16_bf16 v[16:31], v[64:67], v[120:123], v[16:31]
  ds_read_b64_tr_b16 v[88:89], v3 offset:38912
  ds_read_b64_tr_b16 v[90:91], v3 offset:39680
  ds_read_b64_tr_b16 v[92:93], v6 offset:38912
  v_mfma_f32_32x32x16_bf16 v[32:47], v[68:71], v[120:123], v[32:47]
  ds_read_b64_tr_b16 v[94:95], v6 offset:39680
  ds_read_b64_tr_b16 v[96:97], v9 offset:38912
  ds_read_b64_tr_b16 v[98:99], v9 offset:39680
  v_mfma_f32_32x32x16_bf16 v[48:63], v[72:75], v[120:123], v[48:63]
  buffer_load_dwordx4 v[120:123], v11, s[12:15], s90 offen offset:2048 sc1
  s_waitcnt lgkmcnt(6)
  s_waitcnt vmcnt(9)
  v_mfma_f32_32x32x16_bf16 v[16:31], v[76:79], v[124:127], v[16:31]
  ds_read_b64_tr_b16 v[64:65], v3 offset:45056
  ds_read_b64_tr_b16 v[66:67], v3 offset:45824
  ds_read_b64_tr_b16 v[68:69], v6 offset:45056
  v_mfma_f32_32x32x16_bf16 v[32:47], v[80:83], v[124:127], v[32:47]
  ds_read_b64_tr_b16 v[70:71], v6 offset:45824
  ds_read_b64_tr_b16 v[72:73], v9 offset:45056
  ds_read_b64_tr_b16 v[74:75], v9 offset:45824
  v_mfma_f32_32x32x16_bf16 v[48:63], v[84:87], v[124:127], v[48:63]
  s_add_u32 s90, s90, 4096
  buffer_load_dwordx4 v[124:127], v11, s[12:15], s90 offen offset:0 sc1
  s_waitcnt lgkmcnt(6)
  s_waitcnt vmcnt(9)
  v_mfma_f32_32x32x16_bf16 v[16:31], v[88:91], v[128:131], v[16:31]
  ds_read_b64_tr_b16 v[76:77], v3 offset:51200
  ds_read_b64_tr_b16 v[78:79], v3 offset:51968
  ds_read_b64_tr_b16 v[80:81], v6 offset:51200
  v_mfma_f32_32x32x16_bf16 v[32:47], v[92:95], v[128:131], v[32:47]
  ds_read_b64_tr_b16 v[82:83], v6 offset:51968
  ds_read_b64_tr_b16 v[84:85], v9 offset:51200
  ds_read_b64_tr_b16 v[86:87], v9 offset:51968
  v_mfma_f32_32x32x16_bf16 v[48:63], v[96:99], v[128:131], v[48:63]
  buffer_load_dwordx4 v[128:131], v11, s[12:15], s90 offen offset:2048 sc1
  s_waitcnt lgkmcnt(6)
  s_waitcnt vmcnt(9)
  v_mfma_f32_32x32x16_bf16 v[16:31], v[64:67], v[132:135], v[16:31]
  s_waitcnt lgkmcnt(0)
  s_barrier
  ds_read_b64_tr_b16 v[88:89], v3 offset:57344
  ds_read_b64_tr_b16 v[90:91], v3 offset:58112
  ds_read_b64_tr_b16 v[92:93], v6 offset:57344
  v_mfma_f32_32x32x16_bf16 v[32:47], v[68:71], v[132:135], v[32:47]
  ds_read_b64_tr_b16 v[94:95], v6 offset:58112
  ds_read_b64_tr_b16 v[96:97], v9 offset:57344
  ds_read_b64_tr_b16 v[98:99], v9 offset:58112
  v_mfma_f32_32x32x16_bf16 v[48:63], v[72:75], v[132:135], v[48:63]
  s_add_u32 s90, s98, 7
  s_and_b32 s90, s90, 7
  s_add_u32 s90, s90, 0
  s_lshl_b32 s90, s90, 13
  buffer_load_dwordx4 v[132:135], v11, s[12:15], s90 offen offset:0 sc1
  s_waitcnt lgkmcnt(6)
  s_waitcnt vmcnt(9)
  v_mfma_f32_32x32x16_bf16 v[16:31], v[76:79], v[136:139], v[16:31]
  ds_read_b64_tr_b16 v[64:65], v3 offset:63488
  ds_read_b64_tr_b16 v[66:67], v3 offset:64256
  ds_read_b64_tr_b16 v[68:69], v6 offset:63488
  v_mfma_f32_32x32x16_bf16 v[32:47], v[80:83], v[136:139], v[32:47]
  ds_read_b64_tr_b16 v[70:71], v6 offset:64256
  ds_read_b64_tr_b16 v[72:73], v9 offset:63488
  ds_read_b64_tr_b16 v[74:75], v9 offset:64256
  v_mfma_f32_32x32x16_bf16 v[48:63], v[84:87], v[136:139], v[48:63]
  buffer_load_dwordx4 v[136:139], v11, s[12:15], s90 offen offset:2048 sc1
  s_waitcnt lgkmcnt(6)
  s_waitcnt vmcnt(9)
  v_mfma_f32_32x32x16_bf16 v[16:31], v[88:91], v[100:103], v[16:31]
  ds_read_b64_tr_b16 v[76:77], v4 offset:4096
  ds_read_b64_tr_b16 v[78:79], v4 offset:4864
  ds_read_b64_tr_b16 v[80:81], v7 offset:4096
  v_mfma_f32_32x32x16_bf16 v[32:47], v[92:95], v[100:103], v[32:47]
  ds_read_b64_tr_b16 v[82:83], v7 offset:4864
  ds_read_b64_tr_b16 v[84:85], v10 offset:4096
  ds_read_b64_tr_b16 v[86:87], v10 offset:4864
  v_mfma_f32_32x32x16_bf16 v[48:63], v[96:99], v[100:103], v[48:63]
  s_add_u32 s90, s90, 4096
  buffer_load_dwordx4 v[100:103], v11, s[12:15], s90 offen offset:0 sc1
  s_waitcnt lgkmcnt(6)
  s_waitcnt vmcnt(9)
  v_mfma_f32_32x32x16_bf16 v[16:31], v[64:67], v[104:107], v[16:31]
  ds_read_b64_tr_b16 v[88:89], v4 offset:10240
  ds_read_b64_tr_b16 v[90:91], v4 offset:11008
  ds_read_b64_tr_b16 v[92:93], v7 offset:10240
  v_mfma_f32_32x32x16_bf16 v[32:47], v[68:71], v[104:107], v[32:47]
  ds_read_b64_tr_b16 v[94:95], v7 offset:11008
  ds_read_b64_tr_b16 v[96:97], v10 offset:10240
  ds_read_b64_tr_b16 v[98:99], v10 offset:11008
  v_mfma_f32_32x32x16_bf16 v[48:63], v[72:75], v[104:107], v[48:63]
  buffer_load_dwordx4 v[104:107], v11, s[12:15], s90 offen offset:2048 sc1
  s_waitcnt lgkmcnt(6)
  s_waitcnt vmcnt(9)
  v_mfma_f32_32x32x16_bf16 v[16:31], v[76:79], v[108:111], v[16:31]
  s_waitcnt lgkmcnt(0)
  s_barrier
  ds_read_b64_tr_b16 v[64:65], v2 offset:0
  ds_read_b64_tr_b16 v[66:67], v2 offset:768
  ds_read_b64_tr_b16 v[68:69], v5 offset:0
  v_mfma_f32_32x32x16_bf16 v[32:47], v[80:83], v[108:111], v[32:47]
  ds_read_b64_tr_b16 v[70:71], v5 offset:768
  ds_read_b64_tr_b16 v[72:73], v8 offset:0
  ds_read_b64_tr_b16 v[74:75], v8 offset:768
  v_mfma_f32_32x32x16_bf16 v[48:63], v[84:87], v[108:111], v[48:63]
  s_add_u32 s90, s98, 0
  s_and_b32 s90, s90, 7
  s_add_u32 s90, s90, 8
  s_lshl_b32 s90, s90, 13
  buffer_load_dwordx4 v[108:111], v11, s[12:15], s90 offen offset:0 sc1
  s_waitcnt lgkmcnt(6)
  s_waitcnt vmcnt(9)
  v_mfma_f32_32x32x16_bf16 v[16:31], v[88:91], v[112:115], v[16:31]
  ds_read_b64_tr_b16 v[76:77], v2 offset:6144
  ds_read_b64_tr_b16 v[78:79], v2 offset:6912
  ds_read_b64_tr_b16 v[80:81], v5 offset:6144
  v_mfma_f32_32x32x16_bf16 v[32:47], v[92:95], v[112:115], v[32:47]
  ds_read_b64_tr_b16 v[82:83], v5 offset:6912
  ds_read_b64_tr_b16 v[84:85], v8 offset:6144
  ds_read_b64_tr_b16 v[86:87], v8 offset:6912
  v_mfma_f32_32x32x16_bf16 v[48:63], v[96:99], v[112:115], v[48:63]
  buffer_load_dwordx4 v[112:115], v11, s[12:15], s90 offen offset:2048 sc1
  s_waitcnt lgkmcnt(6)
  s_waitcnt vmcnt(9)
  v_mfma_f32_32x32x16_bf16 v[16:31], v[64:67], v[116:119], v[16:31]
  ds_read_b64_tr_b16 v[88:89], v2 offset:12288
  ds_read_b64_tr_b16 v[90:91], v2 offset:13056
  ds_read_b64_tr_b16 v[92:93], v5 offset:12288
  v_mfma_f32_32x32x16_bf16 v[32:47], v[68:71], v[116:119], v[32:47]
  ds_read_b64_tr_b16 v[94:95], v5 offset:13056
  ds_read_b64_tr_b16 v[96:97], v8 offset:12288
  ds_read_b64_tr_b16 v[98:99], v8 offset:13056
  v_mfma_f32_32x32x16_bf16 v[48:63], v[72:75], v[116:119], v[48:63]
  s_add_u32 s90, s90, 4096
  buffer_load_dwordx4 v[116:119], v11, s[12:15], s90 offen offset:0 sc1
  s_waitcnt lgkmcnt(6)
  s_waitcnt vmcnt(9)
  v_mfma_f32_32x32x16_bf16 v[16:31], v[76:79], v[120:123], v[16:31]
  ds_read_b64_tr_b16 v[64:65], v2 offset:18432
  ds_read_b64_tr_b16 v[66:67], v2 offset:19200
  ds_read_b64_tr_b16 v[68:69], v5 offset:18432
  v_mfma_f32_32x32x16_bf16 v[32:47], v[80:83], v[120:123], v[32:47]
  ds_read_b64_tr_b16 v[70:71], v5 offset:19200
  ds_read_b64_tr_b16 v[72:73], v8 offset:18432
  ds_read_b64_tr_b16 v[74:75], v8 offset:19200
  v_mfma_f32_32x32x16_bf16 v[48:63], v[84:87], v[120:123], v[48:63]
  buffer_load_dwordx4 v[120:123], v11, s[12:15], s90 offen offset:2048 sc1
  s_waitcnt lgkmcnt(6)
  s_waitcnt vmcnt(9)
  v_mfma_f32_32x32x16_bf16 v[16:31], v[88:91], v[124:127], v[16:31]
  s_waitcnt lgkmcnt(0)
  s_barrier
  ds_read_b64_tr_b16 v[76:77], v2 offset:24576
  ds_read_b64_tr_b16 v[78:79], v2 offset:25344
  ds_read_b64_tr_b16 v[80:81], v5 offset:24576
  v_mfma_f32_32x32x16_bf16 v[32:47], v[92:95], v[124:127], v[32:47]
  ds_read_b64_tr_b16 v[82:83], v5 offset:25344
  ds_read_b64_tr_b16 v[84:85], v8 offset:24576
  ds_read_b64_tr_b16 v[86:87], v8 offset:25344
  v_mfma_f32_32x32x16_bf16 v[48:63], v[96:99], v[124:127], v[48:63]
  s_add_u32 s90, s98, 1
  s_and_b32 s90, s90, 7
  s_add_u32 s90, s90, 8
  s_lshl_b32 s90, s90, 13
  buffer_load_dwordx4 v[124:127], v11, s[12:15], s90 offen offset:0 sc1
  s_waitcnt lgkmcnt(6)
  s_waitcnt vmcnt(9)
  v_mfma_f32_32x32x16_bf16 v[16:31], v[64:67], v[128:131], v[16:31]
  ds_read_b64_tr_b16 v[88:89], v2 offset:30720
  ds_read_b64_tr_b16 v[90:91], v2 offset:31488
  ds_read_b64_tr_b16 v[92:93], v5 offset:30720
  v_mfma_f32_32x32x16_bf16 v[32:47], v[68:71], v[128:131], v[32:47]
  ds_read_b64_tr_b16 v[94:95], v5 offset:31488
  ds_read_b64_tr_b16 v[96:97], v8 offset:30720
  ds_read_b64_tr_b16 v[98:99], v8 offset:31488
  v_mfma_f32_32x32x16_bf16 v[48:63], v[72:75], v[128:131], v[48:63]
  buffer_load_dwordx4 v[128:131], v11, s[12:15], s90 offen offset:2048 sc1
  s_waitcnt lgkmcnt(6)
  s_waitcnt vmcnt(9)
  v_mfma_f32_32x32x16_bf16 v[16:31], v[76:79], v[132:135], v[16:31]
  ds_read_b64_tr_b16 v[64:65], v2 offset:36864
  ds_read_b64_tr_b16 v[66:67], v2 offset:37632
  ds_read_b64_tr_b16 v[68:69], v5 offset:36864
  v_mfma_f32_32x32x16_bf16 v[32:47], v[80:83], v[132:135], v[32:47]
  ds_read_b64_tr_b16 v[70:71], v5 offset:37632
  ds_read_b64_tr_b16 v[72:73], v8 offset:36864
  ds_read_b64_tr_b16 v[74:75], v8 offset:37632
  v_mfma_f32_32x32x16_bf16 v[48:63], v[84:87], v[132:135], v[48:63]
  s_add_u32 s90, s90, 4096
  buffer_load_dwordx4 v[132:135], v11, s[12:15], s90 offen offset:0 sc1
  s_waitcnt lgkmcnt(6)
  s_waitcnt vmcnt(9)
  v_mfma_f32_32x32x16_bf16 v[16:31], v[88:91], v[136:139], v[16:31]
  ds_read_b64_tr_b16 v[76:77], v2 offset:43008
  ds_read_b64_tr_b16 v[78:79], v2 offset:43776
  ds_read_b64_tr_b16 v[80:81], v5 offset:43008
  v_mfma_f32_32x32x16_bf16 v[32:47], v[92:95], v[136:139], v[32:47]
  ds_read_b64_tr_b16 v[82:83], v5 offset:43776
  ds_read_b64_tr_b16 v[84:85], v8 offset:43008
  ds_read_b64_tr_b16 v[86:87], v8 offset:43776
  v_mfma_f32_32x32x16_bf16 v[48:63], v[96:99], v[136:139], v[48:63]
  buffer_load_dwordx4 v[136:139], v11, s[12:15], s90 offen offset:2048 sc1
  s_waitcnt lgkmcnt(6)
  s_waitcnt vmcnt(9)
  v_mfma_f32_32x32x16_bf16 v[16:31], v[64:67], v[100:103], v[16:31]
  s_waitcnt lgkmcnt(0)
  s_barrier
  ds_read_b64_tr_b16 v[88:89], v2 offset:49152
  ds_read_b64_tr_b16 v[90:91], v2 offset:49920
  ds_read_b64_tr_b16 v[92:93], v5 offset:49152
  v_mfma_f32_32x32x16_bf16 v[32:47], v[68:71], v[100:103], v[32:47]
  ds_read_b64_tr_b16 v[94:95], v5 offset:49920
  ds_read_b64_tr_b16 v[96:97], v8 offset:49152
  ds_read_b64_tr_b16 v[98:99], v8 offset:49920
  v_mfma_f32_32x32x16_bf16 v[48:63], v[72:75], v[100:103], v[48:63]
  s_add_u32 s90, s98, 2
  s_and_b32 s90, s90, 7
  s_add_u32 s90, s90, 8
  s_lshl_b32 s90, s90, 13
  buffer_load_dwordx4 v[100:103], v11, s[12:15], s90 offen offset:0 sc1
  s_waitcnt lgkmcnt(6)
  s_waitcnt vmcnt(9)
  v_mfma_f32_32x32x16_bf16 v[16:31], v[76:79], v[104:107], v[16:31]
  ds_read_b64_tr_b16 v[64:65], v2 offset:55296
  ds_read_b64_tr_b16 v[66:67], v2 offset:56064
  ds_read_b64_tr_b16 v[68:69], v5 offset:55296
  v_mfma_f32_32x32x16_bf16 v[32:47], v[80:83], v[104:107], v[32:47]
  ds_read_b64_tr_b16 v[70:71], v5 offset:56064
  ds_read_b64_tr_b16 v[72:73], v8 offset:55296
  ds_read_b64_tr_b16 v[74:75], v8 offset:56064
  v_mfma_f32_32x32x16_bf16 v[48:63], v[84:87], v[104:107], v[48:63]
  buffer_load_dwordx4 v[104:107], v11, s[12:15], s90 offen offset:2048 sc1
  s_waitcnt lgkmcnt(6)
  s_waitcnt vmcnt(9)
  v_mfma_f32_32x32x16_bf16 v[16:31], v[88:91], v[108:111], v[16:31]
  ds_read_b64_tr_b16 v[76:77], v2 offset:61440
  ds_read_b64_tr_b16 v[78:79], v2 offset:62208
  ds_read_b64_tr_b16 v[80:81], v5 offset:61440
  v_mfma_f32_32x32x16_bf16 v[32:47], v[92:95], v[108:111], v[32:47]
  ds_read_b64_tr_b16 v[82:83], v5 offset:62208
  ds_read_b64_tr_b16 v[84:85], v8 offset:61440
  ds_read_b64_tr_b16 v[86:87], v8 offset:62208
  v_mfma_f32_32x32x16_bf16 v[48:63], v[96:99], v[108:111], v[48:63]
  s_add_u32 s90, s90, 4096
  buffer_load_dwordx4 v[108:111], v11, s[12:15], s90 offen offset:0 sc1
  s_waitcnt lgkmcnt(6)
  s_waitcnt vmcnt(9)
  v_mfma_f32_32x32x16_bf16 v[16:31], v[64:67], v[112:115], v[16:31]
  ds_read_b64_tr_b16 v[88:89], v3 offset:2048
  ds_read_b64_tr_b16 v[90:91], v3 offset:2816
  ds_read_b64_tr_b16 v[92:93], v6 offset:2048
  v_mfma_f32_32x32x16_bf16 v[32:47], v[68:71], v[112:115], v[32:47]
  ds_read_b64_tr_b16 v[94:95], v6 offset:2816
  ds_read_b64_tr_b16 v[96:97], v9 offset:2048
  ds_read_b64_tr_b16 v[98:99], v9 offset:2816
  v_mfma_f32_32x32x16_bf16 v[48:63], v[72:75], v[112:115], v[48:63]
  buffer_load_dwordx4 v[112:115], v11, s[12:15], s90 offen offset:2048 sc1
  s_waitcnt lgkmcnt(6)
  s_waitcnt vmcnt(9)
  v_mfma_f32_32x32x16_bf16 v[16:31], v[76:79], v[116:119], v[16:31]
  s_waitcnt lgkmcnt(0)
  s_barrier
  ds_read_b64_tr_b16 v[64:65], v3 offset:8192
  ds_read_b64_tr_b16 v[66:67], v3 offset:8960
  ds_read_b64_tr_b16 v[68:69], v6 offset:8192
  v_mfma_f32_32x32x16_bf16 v[32:47], v[80:83], v[116:119], v[32:47]
  ds_read_b64_tr_b16 v[70:71], v6 offset:8960
  ds_read_b64_tr_b16 v[72:73], v9 offset:8192
  ds_read_b64_tr_b16 v[74:75], v9 offset:8960
  v_mfma_f32_32x32x16_bf16 v[48:63], v[84:87], v[116:119], v[48:63]
  s_add_u32 s90, s98, 3
  s_and_b32 s90, s90, 7
  s_add_u32 s90, s90, 8
  s_lshl_b32 s90, s90, 13
  buffer_load_dwordx4 v[116:119], v11, s[12:15], s90 offen offset:0 sc1
  s_waitcnt lgkmcnt(6)
  s_waitcnt vmcnt(9)
  v_mfma_f32_32x32x16_bf16 v[16:31], v[88:91], v[120:123], v[16:31]
  ds_read_b64_tr_b16 v[76:77], v3 offset:14336
  ds_read_b64_tr_b16 v[78:79], v3 offset:15104
  ds_read_b64_tr_b16 v[80:81], v6 offset:14336
  v_mfma_f32_32x32x16_bf16 v[32:47], v[92:95], v[120:123], v[32:47]
  ds_read_b64_tr_b16 v[82:83], v6 offset:15104
  ds_read_b64_tr_b16 v[84:85], v9 offset:14336
  ds_read_b64_tr_b16 v[86:87], v9 offset:15104
  v_mfma_f32_32x32x16_bf16 v[48:63], v[96:99], v[120:123], v[48:63]
  buffer_load_dwordx4 v[120:123], v11, s[12:15], s90 offen offset:2048 sc1
  s_waitcnt lgkmcnt(6)
  s_waitcnt vmcnt(9)
  v_mfma_f32_32x32x16_bf16 v[16:31], v[64:67], v[124:127], v[16:31]
  ds_read_b64_tr_b16 v[88:89], v3 offset:20480
  ds_read_b64_tr_b16 v[90:91], v3 offset:21248
  ds_read_b64_tr_b16 v[92:93], v6 offset:20480
  v_mfma_f32_32x32x16_bf16 v[32:47], v[68:71], v[124:127], v[32:47]
  ds_read_b64_tr_b16 v[94:95], v6 offset:21248
  ds_read_b64_tr_b16 v[96:97], v9 offset:20480
  ds_read_b64_tr_b16 v[98:99], v9 offset:21248
  v_mfma_f32_32x32x16_bf16 v[48:63], v[72:75], v[124:127], v[48:63]
  s_add_u32 s90, s90, 4096
  buffer_load_dwordx4 v[124:127], v11, s[12:15], s90 offen offset:0 sc1
  s_waitcnt lgkmcnt(6)
  s_waitcnt vmcnt(9)
  v_mfma_f32_32x32x16_bf16 v[16:31], v[76:79], v[128:131], v[16:31]
  ds_read_b64_tr_b16 v[64:65], v3 offset:26624
  ds_read_b64_tr_b16 v[66:67], v3 offset:27392
  ds_read_b64_tr_b16 v[68:69], v6 offset:26624
  v_mfma_f32_32x32x16_bf16 v[32:47], v[80:83], v[128:131], v[32:47]
  ds_read_b64_tr_b16 v[70:71], v6 offset:27392
  ds_read_b64_tr_b16 v[72:73], v9 offset:26624
  ds_read_b64_tr_b16 v[74:75], v9 offset:27392
  v_mfma_f32_32x32x16_bf16 v[48:63], v[84:87], v[128:131], v[48:63]
  buffer_load_dwordx4 v[128:131], v11, s[12:15], s90 offen offset:2048 sc1
  s_waitcnt lgkmcnt(6)
  s_waitcnt vmcnt(9)
  v_mfma_f32_32x32x16_bf16 v[16:31], v[88:91], v[132:135], v[16:31]
  s_waitcnt lgkmcnt(0)
  s_barrier
  ds_read_b64_tr_b16 v[76:77], v3 offset:32768
  ds_read_b64_tr_b16 v[78:79], v3 offset:33536
  ds_read_b64_tr_b16 v[80:81], v6 offset:32768
  v_mfma_f32_32x32x16_bf16 v[32:47], v[92:95], v[132:135], v[32:47]
  ds_read_b64_tr_b16 v[82:83], v6 offset:33536
  ds_read_b64_tr_b16 v[84:85], v9 offset:32768
  ds_read_b64_tr_b16 v[86:87], v9 offset:33536
  v_mfma_f32_32x32x16_bf16 v[48:63], v[96:99], v[132:135], v[48:63]
  s_add_u32 s90, s98, 4
  s_and_b32 s90, s90, 7
  s_add_u32 s90, s90, 8
  s_lshl_b32 s90, s90, 13
  buffer_load_dwordx4 v[132:135], v11, s[12:15], s90 offen offset:0 sc1
  s_waitcnt lgkmcnt(6)
  s_waitcnt vmcnt(9)
  v_mfma_f32_32x32x16_bf16 v[16:31], v[64:67], v[136:139], v[16:31]
  ds_read_b64_tr_b16 v[88:89], v3 offset:38912
  ds_read_b64_tr_b16 v[90:91], v3 offset:39680
  ds_read_b64_tr_b16 v[92:93], v6 offset:38912
  v_mfma_f32_32x32x16_bf16 v[32:47], v[68:71], v[136:139], v[32:47]
  ds_read_b64_tr_b16 v[94:95], v6 offset:39680
  ds_read_b64_tr_b16 v[96:97], v9 offset:38912
  ds_read_b64_tr_b16 v[98:99], v9 offset:39680
  v_mfma_f32_32x32x16_bf16 v[48:63], v[72:75], v[136:139], v[48:63]
  buffer_load_dwordx4 v[136:139], v11, s[12:15], s90 offen offset:2048 sc1
  s_waitcnt lgkmcnt(6)
  s_waitcnt vmcnt(9)
  v_mfma_f32_32x32x16_bf16 v[16:31], v[76:79], v[100:103], v[16:31]
  ds_read_b64_tr_b16 v[64:65], v3 offset:45056
  ds_read_b64_tr_b16 v[66:67], v3 offset:45824
  ds_read_b64_tr_b16 v[68:69], v6 offset:45056
  v_mfma_f32_32x32x16_bf16 v[32:47], v[80:83], v[100:103], v[32:47]
  ds_read_b64_tr_b16 v[70:71], v6 offset:45824
  ds_read_b64_tr_b16 v[72:73], v9 offset:45056
  ds_read_b64_tr_b16 v[74:75], v9 offset:45824
  v_mfma_f32_32x32x16_bf16 v[48:63], v[84:87], v[100:103], v[48:63]
  s_add_u32 s90, s90, 4096
  buffer_load_dwordx4 v[100:103], v11, s[12:15], s90 offen offset:0 sc1
  s_waitcnt lgkmcnt(6)
  s_waitcnt vmcnt(9)
  v_mfma_f32_32x32x16_bf16 v[16:31], v[88:91], v[104:107], v[16:31]
  ds_read_b64_tr_b16 v[76:77], v3 offset:51200
  ds_read_b64_tr_b16 v[78:79], v3 offset:51968
  ds_read_b64_tr_b16 v[80:81], v6 offset:51200
  v_mfma_f32_32x32x16_bf16 v[32:47], v[92:95], v[104:107], v[32:47]
  ds_read_b64_tr_b16 v[82:83], v6 offset:51968
  ds_read_b64_tr_b16 v[84:85], v9 offset:51200
  ds_read_b64_tr_b16 v[86:87], v9 offset:51968
  v_mfma_f32_32x32x16_bf16 v[48:63], v[96:99], v[104:107], v[48:63]
  buffer_load_dwordx4 v[104:107], v11, s[12:15], s90 offen offset:2048 sc1
  s_waitcnt lgkmcnt(6)
  s_waitcnt vmcnt(9)
  v_mfma_f32_32x32x16_bf16 v[16:31], v[64:67], v[108:111], v[16:31]
  s_waitcnt lgkmcnt(0)
  s_barrier
  ds_read_b64_tr_b16 v[88:89], v3 offset:57344
  ds_read_b64_tr_b16 v[90:91], v3 offset:58112
  ds_read_b64_tr_b16 v[92:93], v6 offset:57344
  v_mfma_f32_32x32x16_bf16 v[32:47], v[68:71], v[108:111], v[32:47]
  ds_read_b64_tr_b16 v[94:95], v6 offset:58112
  ds_read_b64_tr_b16 v[96:97], v9 offset:57344
  ds_read_b64_tr_b16 v[98:99], v9 offset:58112
  v_mfma_f32_32x32x16_bf16 v[48:63], v[72:75], v[108:111], v[48:63]
  s_add_u32 s90, s98, 5
  s_and_b32 s90, s90, 7
  s_add_u32 s90, s90, 8
  s_lshl_b32 s90, s90, 13
  buffer_load_dwordx4 v[108:111], v11, s[12:15], s90 offen offset:0 sc1
  s_waitcnt lgkmcnt(6)
  s_waitcnt vmcnt(9)
  v_mfma_f32_32x32x16_bf16 v[16:31], v[76:79], v[112:115], v[16:31]
  ds_read_b64_tr_b16 v[64:65], v3 offset:63488
  ds_read_b64_tr_b16 v[66:67], v3 offset:64256
  ds_read_b64_tr_b16 v[68:69], v6 offset:63488
  v_mfma_f32_32x32x16_bf16 v[32:47], v[80:83], v[112:115], v[32:47]
  ds_read_b64_tr_b16 v[70:71], v6 offset:64256
  ds_read_b64_tr_b16 v[72:73], v9 offset:63488
  ds_read_b64_tr_b16 v[74:75], v9 offset:64256
  v_mfma_f32_32x32x16_bf16 v[48:63], v[84:87], v[112:115], v[48:63]
  buffer_load_dwordx4 v[112:115], v11, s[12:15], s90 offen offset:2048 sc1
  s_waitcnt lgkmcnt(6)
  s_waitcnt vmcnt(9)
  v_mfma_f32_32x32x16_bf16 v[16:31], v[88:91], v[116:119], v[16:31]
  ds_read_b64_tr_b16 v[76:77], v4 offset:4096
  ds_read_b64_tr_b16 v[78:79], v4 offset:4864
  ds_read_b64_tr_b16 v[80:81], v7 offset:4096
  v_mfma_f32_32x32x16_bf16 v[32:47], v[92:95], v[116:119], v[32:47]
  ds_read_b64_tr_b16 v[82:83], v7 offset:4864
  ds_read_b64_tr_b16 v[84:85], v10 offset:4096
  ds_read_b64_tr_b16 v[86:87], v10 offset:4864
  v_mfma_f32_32x32x16_bf16 v[48:63], v[96:99], v[116:119], v[48:63]
  s_add_u32 s90, s90, 4096
  buffer_load_dwordx4 v[116:119], v11, s[12:15], s90 offen offset:0 sc1
  s_waitcnt lgkmcnt(6)
  s_waitcnt vmcnt(9)
  v_mfma_f32_32x32x16_bf16 v[16:31], v[64:67], v[120:123], v[16:31]
  ds_read_b64_tr_b16 v[88:89], v4 offset:10240
  ds_read_b64_tr_b16 v[90:91], v4 offset:11008
  ds_read_b64_tr_b16 v[92:93], v7 offset:10240
  v_mfma_f32_32x32x16_bf16 v[32:47], v[68:71], v[120:123], v[32:47]
  ds_read_b64_tr_b16 v[94:95], v7 offset:11008
  ds_read_b64_tr_b16 v[96:97], v10 offset:10240
  ds_read_b64_tr_b16 v[98:99], v10 offset:11008
  v_mfma_f32_32x32x16_bf16 v[48:63], v[72:75], v[120:123], v[48:63]
  buffer_load_dwordx4 v[120:123], v11, s[12:15], s90 offen offset:2048 sc1
  s_waitcnt lgkmcnt(6)
  s_waitcnt vmcnt(9)
  v_mfma_f32_32x32x16_bf16 v[16:31], v[76:79], v[124:127], v[16:31]
  s_waitcnt lgkmcnt(0)
  s_barrier
  ds_read_b64_tr_b16 v[64:65], v2 offset:0
  ds_read_b64_tr_b16 v[66:67], v2 offset:768
  ds_read_b64_tr_b16 v[68:69], v5 offset:0
  v_mfma_f32_32x32x16_bf16 v[32:47], v[80:83], v[124:127], v[32:47]
  ds_read_b64_tr_b16 v[70:71], v5 offset:768
  ds_read_b64_tr_b16 v[72:73], v8 offset:0
  ds_read_b64_tr_b16 v[74:75], v8 offset:768
  v_mfma_f32_32x32x16_bf16 v[48:63], v[84:87], v[124:127], v[48:63]
  s_add_u32 s90, s98, 6
  s_and_b32 s90, s90, 7
  s_add_u32 s90, s90, 8
  s_lshl_b32 s90, s90, 13
  buffer_load_dwordx4 v[124:127], v11, s[12:15], s90 offen offset:0 sc1
  s_waitcnt lgkmcnt(6)
  s_waitcnt vmcnt(9)
  v_mfma_f32_32x32x16_bf16 v[16:31], v[88:91], v[128:131], v[16:31]
  ds_read_b64_tr_b16 v[76:77], v2 offset:6144
  ds_read_b64_tr_b16 v[78:79], v2 offset:6912
  ds_read_b64_tr_b16 v[80:81], v5 offset:6144
  v_mfma_f32_32x32x16_bf16 v[32:47], v[92:95], v[128:131], v[32:47]
  ds_read_b64_tr_b16 v[82:83], v5 offset:6912
  ds_read_b64_tr_b16 v[84:85], v8 offset:6144
  ds_read_b64_tr_b16 v[86:87], v8 offset:6912
  v_mfma_f32_32x32x16_bf16 v[48:63], v[96:99], v[128:131], v[48:63]
  buffer_load_dwordx4 v[128:131], v11, s[12:15], s90 offen offset:2048 sc1
  s_waitcnt lgkmcnt(6)
  s_waitcnt vmcnt(9)
  v_mfma_f32_32x32x16_bf16 v[16:31], v[64:67], v[132:135], v[16:31]
  ds_read_b64_tr_b16 v[88:89], v2 offset:12288
  ds_read_b64_tr_b16 v[90:91], v2 offset:13056
  ds_read_b64_tr_b16 v[92:93], v5 offset:12288
  v_mfma_f32_32x32x16_bf16 v[32:47], v[68:71], v[132:135], v[32:47]
  ds_read_b64_tr_b16 v[94:95], v5 offset:13056
  ds_read_b64_tr_b16 v[96:97], v8 offset:12288
  ds_read_b64_tr_b16 v[98:99], v8 offset:13056
  v_mfma_f32_32x32x16_bf16 v[48:63], v[72:75], v[132:135], v[48:63]
  s_add_u32 s90, s90, 4096
  buffer_load_dwordx4 v[132:135], v11, s[12:15], s90 offen offset:0 sc1
  s_waitcnt lgkmcnt(6)
  s_waitcnt vmcnt(9)
  v_mfma_f32_32x32x16_bf16 v[16:31], v[76:79], v[136:139], v[16:31]
  ds_read_b64_tr_b16 v[64:65], v2 offset:18432
  ds_read_b64_tr_b16 v[66:67], v2 offset:19200
  ds_read_b64_tr_b16 v[68:69], v5 offset:18432
  v_mfma_f32_32x32x16_bf16 v[32:47], v[80:83], v[136:139], v[32:47]
  ds_read_b64_tr_b16 v[70:71], v5 offset:19200
  ds_read_b64_tr_b16 v[72:73], v8 offset:18432
  ds_read_b64_tr_b16 v[74:75], v8 offset:19200
  v_mfma_f32_32x32x16_bf16 v[48:63], v[84:87], v[136:139], v[48:63]
  buffer_load_dwordx4 v[136:139], v11, s[12:15], s90 offen offset:2048 sc1
  s_waitcnt lgkmcnt(6)
  s_waitcnt vmcnt(9)
  v_mfma_f32_32x32x16_bf16 v[16:31], v[88:91], v[100:103], v[16:31]
  s_waitcnt lgkmcnt(0)
  s_barrier
  ds_read_b64_tr_b16 v[76:77], v2 offset:24576
  ds_read_b64_tr_b16 v[78:79], v2 offset:25344
  ds_read_b64_tr_b16 v[80:81], v5 offset:24576
  v_mfma_f32_32x32x16_bf16 v[32:47], v[92:95], v[100:103], v[32:47]
  ds_read_b64_tr_b16 v[82:83], v5 offset:25344
  ds_read_b64_tr_b16 v[84:85], v8 offset:24576
  ds_read_b64_tr_b16 v[86:87], v8 offset:25344
  v_mfma_f32_32x32x16_bf16 v[48:63], v[96:99], v[100:103], v[48:63]
  s_add_u32 s90, s98, 7
  s_and_b32 s90, s90, 7
  s_add_u32 s90, s90, 8
  s_lshl_b32 s90, s90, 13
  buffer_load_dwordx4 v[100:103], v11, s[12:15], s90 offen offset:0 sc1
  s_waitcnt lgkmcnt(6)
  s_waitcnt vmcnt(9)
  v_mfma_f32_32x32x16_bf16 v[16:31], v[64:67], v[104:107], v[16:31]
  ds_read_b64_tr_b16 v[88:89], v2 offset:30720
  ds_read_b64_tr_b16 v[90:91], v2 offset:31488
  ds_read_b64_tr_b16 v[92:93], v5 offset:30720
  v_mfma_f32_32x32x16_bf16 v[32:47], v[68:71], v[104:107], v[32:47]
  ds_read_b64_tr_b16 v[94:95], v5 offset:31488
  ds_read_b64_tr_b16 v[96:97], v8 offset:30720
  ds_read_b64_tr_b16 v[98:99], v8 offset:31488
  v_mfma_f32_32x32x16_bf16 v[48:63], v[72:75], v[104:107], v[48:63]
  buffer_load_dwordx4 v[104:107], v11, s[12:15], s90 offen offset:2048 sc1
  s_waitcnt lgkmcnt(6)
  s_waitcnt vmcnt(9)
  v_mfma_f32_32x32x16_bf16 v[16:31], v[76:79], v[108:111], v[16:31]
  ds_read_b64_tr_b16 v[64:65], v2 offset:36864
  ds_read_b64_tr_b16 v[66:67], v2 offset:37632
  ds_read_b64_tr_b16 v[68:69], v5 offset:36864
  v_mfma_f32_32x32x16_bf16 v[32:47], v[80:83], v[108:111], v[32:47]
  ds_read_b64_tr_b16 v[70:71], v5 offset:37632
  ds_read_b64_tr_b16 v[72:73], v8 offset:36864
  ds_read_b64_tr_b16 v[74:75], v8 offset:37632
  v_mfma_f32_32x32x16_bf16 v[48:63], v[84:87], v[108:111], v[48:63]
  s_add_u32 s90, s90, 4096
  buffer_load_dwordx4 v[108:111], v11, s[12:15], s90 offen offset:0 sc1
  s_waitcnt lgkmcnt(6)
  s_waitcnt vmcnt(9)
  v_mfma_f32_32x32x16_bf16 v[16:31], v[88:91], v[112:115], v[16:31]
  ds_read_b64_tr_b16 v[76:77], v2 offset:43008
  ds_read_b64_tr_b16 v[78:79], v2 offset:43776
  ds_read_b64_tr_b16 v[80:81], v5 offset:43008
  v_mfma_f32_32x32x16_bf16 v[32:47], v[92:95], v[112:115], v[32:47]
  ds_read_b64_tr_b16 v[82:83], v5 offset:43776
  ds_read_b64_tr_b16 v[84:85], v8 offset:43008
  ds_read_b64_tr_b16 v[86:87], v8 offset:43776
  v_mfma_f32_32x32x16_bf16 v[48:63], v[96:99], v[112:115], v[48:63]
  buffer_load_dwordx4 v[112:115], v11, s[12:15], s90 offen offset:2048 sc1
  s_waitcnt lgkmcnt(6)
  s_waitcnt vmcnt(9)
  v_mfma_f32_32x32x16_bf16 v[16:31], v[64:67], v[116:119], v[16:31]
  s_waitcnt lgkmcnt(0)
  s_barrier
  ds_read_b64_tr_b16 v[88:89], v2 offset:49152
  ds_read_b64_tr_b16 v[90:91], v2 offset:49920
  ds_read_b64_tr_b16 v[92:93], v5 offset:49152
  v_mfma_f32_32x32x16_bf16 v[32:47], v[68:71], v[116:119], v[32:47]
  ds_read_b64_tr_b16 v[94:95], v5 offset:49920
  ds_read_b64_tr_b16 v[96:97], v8 offset:49152
  ds_read_b64_tr_b16 v[98:99], v8 offset:49920
  v_mfma_f32_32x32x16_bf16 v[48:63], v[72:75], v[116:119], v[48:63]
  s_waitcnt lgkmcnt(6)
  s_waitcnt vmcnt(8)
  v_mfma_f32_32x32x16_bf16 v[16:31], v[76:79], v[120:123], v[16:31]
  ds_read_b64_tr_b16 v[64:65], v2 offset:55296
  ds_read_b64_tr_b16 v[66:67], v2 offset:56064
  ds_read_b64_tr_b16 v[68:69], v5 offset:55296
  v_mfma_f32_32x32x16_bf16 v[32:47], v[80:83], v[120:123], v[32:47]
  ds_read_b64_tr_b16 v[70:71], v5 offset:56064
  ds_read_b64_tr_b16 v[72:73], v8 offset:55296
  ds_read_b64_tr_b16 v[74:75], v8 offset:56064
  v_mfma_f32_32x32x16_bf16 v[48:63], v[84:87], v[120:123], v[48:63]
  s_waitcnt lgkmcnt(6)
  s_waitcnt vmcnt(7)
  v_mfma_f32_32x32x16_bf16 v[16:31], v[88:91], v[124:127], v[16:31]
  ds_read_b64_tr_b16 v[76:77], v2 offset:61440
  ds_read_b64_tr_b16 v[78:79], v2 offset:62208
  ds_read_b64_tr_b16 v[80:81], v5 offset:61440
  v_mfma_f32_32x32x16_bf16 v[32:47], v[92:95], v[124:127], v[32:47]
  ds_read_b64_tr_b16 v[82:83], v5 offset:62208
  ds_read_b64_tr_b16 v[84:85], v8 offset:61440
  ds_read_b64_tr_b16 v[86:87], v8 offset:62208
  v_mfma_f32_32x32x16_bf16 v[48:63], v[96:99], v[124:127], v[48:63]
  s_waitcnt lgkmcnt(6)
  s_waitcnt vmcnt(6)
  v_mfma_f32_32x32x16_bf16 v[16:31], v[64:67], v[128:131], v[16:31]
  ds_read_b64_tr_b16 v[88:89], v3 offset:2048
  ds_read_b64_tr_b16 v[90:91], v3 offset:2816
  ds_read_b64_tr_b16 v[92:93], v6 offset:2048
  v_mfma_f32_32x32x16_bf16 v[32:47], v[68:71], v[128:131], v[32:47]
  ds_read_b64_tr_b16 v[94:95], v6 offset:2816
  ds_read_b64_tr_b16 v[96:97], v9 offset:2048
  ds_read_b64_tr_b16 v[98:99], v9 offset:2816
  v_mfma_f32_32x32x16_bf16 v[48:63], v[72:75], v[128:131], v[48:63]
  s_waitcnt lgkmcnt(6)
  s_waitcnt vmcnt(5)
  v_mfma_f32_32x32x16_bf16 v[16:31], v[76:79], v[132:135], v[16:31]
  s_waitcnt lgkmcnt(0)
  s_barrier
  ds_read_b64_tr_b16 v[64:65], v3 offset:8192
  ds_read_b64_tr_b16 v[66:67], v3 offset:8960
  ds_read_b64_tr_b16 v[68:69], v6 offset:8192
  v_mfma_f32_32x32x16_bf16 v[32:47], v[80:83], v[132:135], v[32:47]
  ds_read_b64_tr_b16 v[70:71], v6 offset:8960
  ds_read_b64_tr_b16 v[72:73], v9 offset:8192
  ds_read_b64_tr_b16 v[74:75], v9 offset:8960
  v_mfma_f32_32x32x16_bf16 v[48:63], v[84:87], v[132:135], v[48:63]
  s_waitcnt lgkmcnt(6)
  s_waitcnt vmcnt(4)
  v_mfma_f32_32x32x16_bf16 v[16:31], v[88:91], v[136:139], v[16:31]
  ds_read_b64_tr_b16 v[76:77], v3 offset:14336
  ds_read_b64_tr_b16 v[78:79], v3 offset:15104
  ds_read_b64_tr_b16 v[80:81], v6 offset:14336
  v_mfma_f32_32x32x16_bf16 v[32:47], v[92:95], v[136:139], v[32:47]
  ds_read_b64_tr_b16 v[82:83], v6 offset:15104
  ds_read_b64_tr_b16 v[84:85], v9 offset:14336
  ds_read_b64_tr_b16 v[86:87], v9 offset:15104
  v_mfma_f32_32x32x16_bf16 v[48:63], v[96:99], v[136:139], v[48:63]
  s_waitcnt lgkmcnt(6)
  s_waitcnt vmcnt(3)
  v_mfma_f32_32x32x16_bf16 v[16:31], v[64:67], v[100:103], v[16:31]
  ds_read_b64_tr_b16 v[88:89], v3 offset:20480
  ds_read_b64_tr_b16 v[90:91], v3 offset:21248
  ds_read_b64_tr_b16 v[92:93], v6 offset:20480
  v_mfma_f32_32x32x16_bf16 v[32:47], v[68:71], v[100:103], v[32:47]
  ds_read_b64_tr_b16 v[94:95], v6 offset:21248
  ds_read_b64_tr_b16 v[96:97], v9 offset:20480
  ds_read_b64_tr_b16 v[98:99], v9 offset:21248
  v_mfma_f32_32x32x16_bf16 v[48:63], v[72:75], v[100:103], v[48:63]
  s_waitcnt lgkmcnt(6)
  s_waitcnt vmcnt(2)
  v_mfma_f32_32x32x16_bf16 v[16:31], v[76:79], v[104:107], v[16:31]
  ds_read_b64_tr_b16 v[64:65], v3 offset:26624
  ds_read_b64_tr_b16 v[66:67], v3 offset:27392
  ds_read_b64_tr_b16 v[68:69], v6 offset:26624
  v_mfma_f32_32x32x16_bf16 v[32:47], v[80:83], v[104:107], v[32:47]
  ds_read_b64_tr_b16 v[70:71], v6 offset:27392
  ds_read_b64_tr_b16 v[72:73], v9 offset:26624
  ds_read_b64_tr_b16 v[74:75], v9 offset:27392
  v_mfma_f32_32x32x16_bf16 v[48:63], v[84:87], v[104:107], v[48:63]
  s_waitcnt lgkmcnt(6)
  s_waitcnt vmcnt(1)
  v_mfma_f32_32x32x16_bf16 v[16:31], v[88:91], v[108:111], v[16:31]
  v_mfma_f32_32x32x16_bf16 v[32:47], v[92:95], v[108:111], v[32:47]
  v_mfma_f32_32x32x16_bf16 v[48:63], v[96:99], v[108:111], v[48:63]
  s_waitcnt lgkmcnt(0)
  s_waitcnt vmcnt(0)
  v_mfma_f32_32x32x16_bf16 v[16:31], v[64:67], v[112:115], v[16:31]
  v_mfma_f32_32x32x16_bf16 v[32:47], v[68:71], v[112:115], v[32:47]
  v_mfma_f32_32x32x16_bf16 v[48:63], v[72:75], v[112:115], v[48:63]
  s_mul_i32 s28, s24, 6144
  s_add_u32 s28, s28, 98304
  v_lshl_add_u32 v2, v1, 4, s28
  s_xor_b32 s28, s24, 1
  s_mul_i32 s28, s28, 6144
  s_add_u32 s28, s28, 98304
  v_lshl_add_u32 v3, v1, 4, s28
  s_cmp_eq_u32 s91, 1
  s_cselect_b64 s[32:33], -1, 0
  s_nop 1
  v_cndmask_b32 v72, v40, v32, s[32:33]
  v_cndmask_b32 v64, v32, v40, s[32:33]
  v_cndmask_b32 v73, v41, v33, s[32:33]
  v_cndmask_b32 v65, v33, v41, s[32:33]
  v_cndmask_b32 v74, v42, v34, s[32:33]
  v_cndmask_b32 v66, v34, v42, s[32:33]
  v_cndmask_b32 v75, v43, v35, s[32:33]
  v_cndmask_b32 v67, v35, v43, s[32:33]
  v_cndmask_b32 v76, v44, v36, s[32:33]
  v_cndmask_b32 v68, v36, v44, s[32:33]
  v_cndmask_b32 v77, v45, v37, s[32:33]
  v_cndmask_b32 v69, v37, v45, s[32:33]
  v_cndmask_b32 v78, v46, v38, s[32:33]
  v_cndmask_b32 v70, v38, v46, s[32:33]
  v_cndmask_b32 v79, v47, v39, s[32:33]
  v_cndmask_b32 v71, v39, v47, s[32:33]
  ds_write_b128 v3, v[72:75] offset:4096
  ds_write_b128 v3, v[76:79] offset:5120
  ds_write_b128 v3, v[48:51] offset:0
  ds_write_b128 v3, v[52:55] offset:1024
  ds_write_b128 v3, v[56:59] offset:2048
  ds_write_b128 v3, v[60:63] offset:3072
  v_lshlrev_b32 v32, 16, v188
  v_and_b32 v33, 0xffff0000, v188
  v_lshlrev_b32 v34, 16, v189
  v_and_b32 v35, 0xffff0000, v189
  v_lshlrev_b32 v36, 16, v190
  v_and_b32 v37, 0xffff0000, v190
  v_lshlrev_b32 v38, 16, v191
  v_and_b32 v39, 0xffff0000, v191
  v_pk_add_f32 v[32:33], v[32:33], v[64:65]
  v_pk_add_f32 v[34:35], v[34:35], v[66:67]
  v_pk_add_f32 v[36:37], v[36:37], v[68:69]
  v_pk_add_f32 v[38:39], v[38:39], v[70:71]
  s_mov_b32 s34, 0xbdd2d3e8
  s_mov_b32 s35, 0xbdd2d3e8
  v_mov_b32 v12, 0xc0135761
  v_mov_b32 v13, 0xc0135761
  s_lshl_b32 s28, s95, 1
  s_add_u32 s28, s28, s92
  s_mul_i32 s86, s28, 90
  s_mul_i32 s87, s94, 6
  s_add_u32 s86, s86, s87
  s_lshl_b32 s86, s86, 10
  s_add_u32 s86, s86, 6291456
  v_lshl_add_u32 v14, v1, 4, s86
  s_lshl_b32 s36, s91, 12
  s_lshl_b32 s37, s91, 10
  s_add_u32 s37, s37, 2048
  s_lshl_b32 s28, s28, 5
  s_lshl_b32 s86, s94, 1
  s_add_u32 s28, s28, s86
  s_add_u32 s28, s28, s91
  s_lshl_b32 s28, s28, 7
  s_add_u32 s28, s28, 10653696
  v_mov_b32 v15, s28
  v_mov_b32 v11, s31
  s_cmp_eq_u32 s94, 14
  s_cselect_b32 s38, 0, -1
  s_waitcnt lgkmcnt(0)
  s_barrier
  ds_read_b128 v[64:67], v2 offset:0
  ds_read_b128 v[68:71], v2 offset:1024
  ds_read_b128 v[72:75], v2 offset:2048
  ds_read_b128 v[76:79], v2 offset:3072
  ds_read_b128 v[80:83], v2 offset:4096
  ds_read_b128 v[84:87], v2 offset:5120
  s_waitcnt lgkmcnt(0)
  v_pk_add_f32 v[16:17], v[16:17], v[64:65]
  v_pk_add_f32 v[18:19], v[18:19], v[66:67]
  v_pk_add_f32 v[20:21], v[20:21], v[68:69]
  v_pk_add_f32 v[22:23], v[22:23], v[70:71]
  v_pk_add_f32 v[24:25], v[24:25], v[72:73]
  v_pk_add_f32 v[26:27], v[26:27], v[74:75]
  v_pk_add_f32 v[28:29], v[28:29], v[76:77]
  v_pk_add_f32 v[30:31], v[30:31], v[78:79]
  v_pk_add_f32 v[32:33], v[32:33], v[80:81]
  v_pk_add_f32 v[34:35], v[34:35], v[82:83]
  v_pk_add_f32 v[36:37], v[36:37], v[84:85]
  v_pk_add_f32 v[38:39], v[38:39], v[86:87]
  v_pk_mul_f32 v[64:65], v[16:17], v[16:17]
  v_pk_mul_f32 v[66:67], v[18:19], v[18:19]
  v_pk_mul_f32 v[68:69], v[20:21], v[20:21]
  v_pk_mul_f32 v[70:71], v[22:23], v[22:23]
  v_pk_mul_f32 v[72:73], v[24:25], v[24:25]
  v_pk_mul_f32 v[74:75], v[26:27], v[26:27]
  v_pk_mul_f32 v[76:77], v[28:29], v[28:29]
  v_pk_mul_f32 v[78:79], v[30:31], v[30:31]
  v_pk_mul_f32 v[80:81], v[32:33], v[32:33]
  v_pk_mul_f32 v[82:83], v[34:35], v[34:35]
  v_pk_mul_f32 v[84:85], v[36:37], v[36:37]
  v_pk_mul_f32 v[86:87], v[38:39], v[38:39]
  v_pk_fma_f32 v[64:65], v[64:65], s[34:35], v[12:13]
  v_pk_fma_f32 v[66:67], v[66:67], s[34:35], v[12:13]
  v_pk_fma_f32 v[68:69], v[68:69], s[34:35], v[12:13]
  v_pk_fma_f32 v[70:71], v[70:71], s[34:35], v[12:13]
  v_pk_fma_f32 v[72:73], v[72:73], s[34:35], v[12:13]
  v_pk_fma_f32 v[74:75], v[74:75], s[34:35], v[12:13]
  v_pk_fma_f32 v[76:77], v[76:77], s[34:35], v[12:13]
  v_pk_fma_f32 v[78:79], v[78:79], s[34:35], v[12:13]
  v_pk_fma_f32 v[80:81], v[80:81], s[34:35], v[12:13]
  v_pk_fma_f32 v[82:83], v[82:83], s[34:35], v[12:13]
  v_pk_fma_f32 v[84:85], v[84:85], s[34:35], v[12:13]
  v_pk_fma_f32 v[86:87], v[86:87], s[34:35], v[12:13]
  v_pk_mul_f32 v[64:65], v[64:65], v[16:17]
  v_pk_mul_f32 v[66:67], v[66:67], v[18:19]
  v_pk_mul_f32 v[68:69], v[68:69], v[20:21]
  v_pk_mul_f32 v[70:71], v[70:71], v[22:23]
  v_pk_mul_f32 v[72:73], v[72:73], v[24:25]
  v_pk_mul_f32 v[74:75], v[74:75], v[26:27]
  v_pk_mul_f32 v[76:77], v[76:77], v[28:29]
  v_pk_mul_f32 v[78:79], v[78:79], v[30:31]
  v_pk_mul_f32 v[80:81], v[80:81], v[32:33]
  v_pk_mul_f32 v[82:83], v[82:83], v[34:35]
  v_pk_mul_f32 v[84:85], v[84:85], v[36:37]
  v_pk_mul_f32 v[86:87], v[86:87], v[38:39]
  v_exp_f32 v64, v64
  v_exp_f32 v65, v65
  v_exp_f32 v66, v66
  v_exp_f32 v67, v67
  v_exp_f32 v68, v68
  v_exp_f32 v69, v69
  v_exp_f32 v70, v70
  v_exp_f32 v71, v71
  v_exp_f32 v72, v72
  v_exp_f32 v73, v73
  v_exp_f32 v74, v74
  v_exp_f32 v75, v75
  v_exp_f32 v76, v76
  v_exp_f32 v77, v77
  v_exp_f32 v78, v78
  v_exp_f32 v79, v79
  v_exp_f32 v80, v80
  v_exp_f32 v81, v81
  v_exp_f32 v82, v82
  v_exp_f32 v83, v83
  v_exp_f32 v84, v84
  v_exp_f32 v85, v85
  v_exp_f32 v86, v86
  v_exp_f32 v87, v87
  v_pk_add_f32 v[64:65], v[64:65], 1.0 op_sel_hi:[1,0]
  v_pk_add_f32 v[66:67], v[66:67], 1.0 op_sel_hi:[1,0]
  v_pk_add_f32 v[68:69], v[68:69], 1.0 op_sel_hi:[1,0]
  v_pk_add_f32 v[70:71], v[70:71], 1.0 op_sel_hi:[1,0]
  v_pk_add_f32 v[72:73], v[72:73], 1.0 op_sel_hi:[1,0]
  v_pk_add_f32 v[74:75], v[74:75], 1.0 op_sel_hi:[1,0]
  v_pk_add_f32 v[76:77], v[76:77], 1.0 op_sel_hi:[1,0]
  v_pk_add_f32 v[78:79], v[78:79], 1.0 op_sel_hi:[1,0]
  v_pk_add_f32 v[80:81], v[80:81], 1.0 op_sel_hi:[1,0]
  v_pk_add_f32 v[82:83], v[82:83], 1.0 op_sel_hi:[1,0]
  v_pk_add_f32 v[84:85], v[84:85], 1.0 op_sel_hi:[1,0]
  v_pk_add_f32 v[86:87], v[86:87], 1.0 op_sel_hi:[1,0]
  v_rcp_f32 v64, v64
  v_rcp_f32 v65, v65
  v_rcp_f32 v66, v66
  v_rcp_f32 v67, v67
  v_rcp_f32 v68, v68
  v_rcp_f32 v69, v69
  v_rcp_f32 v70, v70
  v_rcp_f32 v71, v71
  v_rcp_f32 v72, v72
  v_rcp_f32 v73, v73
  v_rcp_f32 v74, v74
  v_rcp_f32 v75, v75
  v_rcp_f32 v76, v76
  v_rcp_f32 v77, v77
  v_rcp_f32 v78, v78
  v_rcp_f32 v79, v79
  v_rcp_f32 v80, v80
  v_rcp_f32 v81, v81
  v_rcp_f32 v82, v82
  v_rcp_f32 v83, v83
  v_rcp_f32 v84, v84
  v_rcp_f32 v85, v85
  v_rcp_f32 v86, v86
  v_rcp_f32 v87, v87
  v_pk_mul_f32 v[64:65], v[64:65], v[16:17]
  v_pk_mul_f32 v[66:67], v[66:67], v[18:19]
  v_pk_mul_f32 v[68:69], v[68:69], v[20:21]
  v_pk_mul_f32 v[70:71], v[70:71], v[22:23]
  v_pk_mul_f32 v[72:73], v[72:73], v[24:25]
  v_pk_mul_f32 v[74:75], v[74:75], v[26:27]
  v_pk_mul_f32 v[76:77], v[76:77], v[28:29]
  v_pk_mul_f32 v[78:79], v[78:79], v[30:31]
  v_pk_mul_f32 v[80:81], v[80:81], v[32:33]
  v_pk_mul_f32 v[82:83], v[82:83], v[34:35]
  v_pk_mul_f32 v[84:85], v[84:85], v[36:37]
  v_pk_mul_f32 v[86:87], v[86:87], v[38:39]
  v_cvt_pk_bf16_f32 v48, v64, v65
  v_cvt_pk_bf16_f32 v49, v66, v67
  v_cvt_pk_bf16_f32 v50, v68, v69
  v_cvt_pk_bf16_f32 v51, v70, v71
  v_cvt_pk_bf16_f32 v52, v72, v73
  v_cvt_pk_bf16_f32 v53, v74, v75
  v_cvt_pk_bf16_f32 v54, v76, v77
  v_cvt_pk_bf16_f32 v55, v78, v79
  v_cvt_pk_bf16_f32 v56, v80, v81
  v_cvt_pk_bf16_f32 v57, v82, v83
  v_cvt_pk_bf16_f32 v58, v84, v85
  v_cvt_pk_bf16_f32 v59, v86, v87
  v_and_b32 v56, s38, v56
  v_and_b32 v57, s38, v57
  v_and_b32 v58, s38, v58
  v_and_b32 v59, s38, v59
  buffer_store_dwordx4 v[48:51], v14, s[12:15], s36 offen sc1
  buffer_store_dwordx4 v[52:55], v14, s[12:15], s36 offen offset:1024 sc1
  buffer_store_dwordx4 v[56:59], v14, s[12:15], s37 offen sc1
  s_waitcnt vmcnt(0)
  s_mov_b64 exec, 1
  buffer_store_dword v11, v15, s[12:15], 0 offen sc1
  s_mov_b64 exec, -1
F_cons:
  s_barrier
  v_mov_b32 v252, 10485888
  v_mov_b32 v253, 0
F_cons2:
  s_and_b32 s91, s24, 1
  s_lshr_b32 s92, s24, 1
  v_lshrrev_b32 v9, 5, v1
  s_lshl_b32 s28, s29, 6
  s_lshl_b32 s86, s92, 5
  s_add_u32 s28, s28, s86
  v_and_b32 v10, 31, v1
  v_add_u32 v10, s28, v10
  v_lshlrev_b32 v11, 1, v10
  v_lshlrev_b32 v14, 10, v10
  s_lshl_b32 s28, s30, 7
  s_lshl_b32 s86, s91, 6
  s_add_u32 s28, s28, s86
  v_add_u32 v14, s28, v14
  v_lshl_add_u32 v15, v9, 4, v14
  v_lshl_add_u32 v14, v9, 3, v14
  s_mov_b32 s4, s64
  s_mov_b32 s5, s65
  s_mov_b32 s6, 2097152
  s_mov_b32 s7, 0x00020000
  s_mov_b32 s8, s78
  s_mov_b32 s9, s79
  s_mov_b32 s10, 4096
  s_mov_b32 s11, 0x00020000
  buffer_load_dwordx2 v[64:65], v14, s[4:7], 0 offen offset:0
  buffer_load_dwordx2 v[66:67], v14, s[4:7], 0 offen offset:16
  buffer_load_dwordx2 v[68:69], v14, s[4:7], 0 offen offset:32
  buffer_load_dwordx2 v[70:71], v14, s[4:7], 0 offen offset:48
  buffer_load_ushort v72, v11, s[8:11], 0 offen
  v_bfe_u32 v10, v1, 4, 1
  v_lshlrev_b32 v10, 1, v10
  v_bfe_u32 v11, v1, 1, 1
  v_add_u32 v10, v10, v11
  v_bfe_u32 v11, v1, 3, 1
  v_lshl_add_u32 v10, v11, 2, v10
  v_lshlrev_b32 v10, 4, v10
  v_and_b32 v11, 1, v1
  v_lshl_add_u32 v10, v11, 3, v10
  v_bfe_u32 v11, v1, 2, 2
  v_lshl_add_u32 v10, v11, 7, v10
  v_lshl_add_u32 v8, v9, 9, v10
  s_lshl_b32 s28, s30, 1
  s_add_u32 s28, s28, s91
  s_lshl_b32 s86, s28, 12
  s_add_u32 s86, s86, 10653696
  v_lshl_add_u32 v12, v1, 7, s86
  s_mov_b32 s88, s86
  s_mul_i32 s28, s28, 92160
  s_lshl_b32 s86, s92, 10
  s_add_u32 s28, s28, s86
  s_add_u32 s28, s28, 6291456
  v_lshl_add_u32 v10, v1, 4, s28
  s_lshl_b32 s28, s29, 1
  s_add_u32 s28, s28, s92
  s_lshl_b32 s86, s28, 11
  s_add_u32 s86, s86, 10719232
  v_lshl_add_u32 v13, v1, 7, s86
  s_lshl_b32 s28, s28, 15
  s_lshl_b32 s86, s91, 10
  s_add_u32 s28, s28, s86
  s_add_u32 s28, s28, 8388608
  v_lshl_add_u32 v11, v1, 4, s28
  s_mul_i32 s28, s92, 2112
  v_xor_b32 v2, s28, v8
  v_xor_b32 v5, 64, v2
  v_add_u32 v3, 0x10000, v2
  v_add_u32 v4, 0x20000, v2
  v_add_u32 v6, 0x10000, v5
  v_add_u32 v7, 0x20000, v5
  s_lshl_b32 s28, s24, 12
  s_add_u32 s28, s28, 49152
  v_lshl_add_u32 v9, v1, 4, s28
  v_xor_b32 v246, 8192, v9
  v_xor_b32 v247, 4096, v9
  s_bitcmp1_b32 s2, 3
  s_cselect_b32 s28, s94, s95
  s_cselect_b32 s86, 15, 0
  s_sub_u32 s28, s28, s86
  s_cmp_ge_u32 s28, 2
  s_cbranch_scc1 F_pe_ok
  s_mov_b64 exec, 1
  s_mov_b32 s93, 0
F_pe:
  buffer_load_dword v14, v12, s[12:15], 0 offen sc1
  s_add_u32 s93, s93, 1
  s_waitcnt vmcnt(0)
  v_cmp_ne_u32 vcc, s31, v14
  s_cmp_ge_u32 s93, 100000
  s_cbranch_scc1 F_pe_ok
  s_nop 1
  s_cbranch_vccz F_pe_ok
  s_sleep 16
  s_branch F_pe
F_pe_ok:
  s_mov_b64 exec, -1
  s_mov_b32 exec_lo, 0x3fffffff
  s_mov_b32 exec_hi, 0x0
  buffer_load_dword v14, v12, s[12:15], 0 offen sc1
  s_waitcnt vmcnt(6)
  s_bitcmp1_b32 s2, 3
  s_cbranch_scc1 F_nof
  s_mov_b64 exec, 1
  buffer_store_dword v253, v252, s[12:15], 0 offen sc1
  s_mov_b32 exec_lo, 0x3fffffff
  s_mov_b32 exec_hi, 0x0
  s_waitcnt vmcnt(1)
  s_branch F_nof2
F_nof:
  s_waitcnt vmcnt(0)
F_nof2:
  v_cmp_ne_u32 vcc, s31, v14
  s_nop 3
  s_cbranch_vccz F_poll0_ok
  s_sleep 4
  s_mov_b32 exec_lo, 0x3fffffff
  s_mov_b32 exec_hi, 0x0
  s_mov_b32 s93, 0
F_poll0:
  buffer_load_dword v14, v12, s[12:15], 0 offen sc1
  s_add_u32 s93, s93, 1
  s_waitcnt vmcnt(0)
  v_cmp_ne_u32 vcc, s31, v14
  s_cmp_ge_u32 s93, 100000
  s_cbranch_scc1 F_poll0_ok
  s_nop 1
  s_cbranch_vccz F_poll0_ok
  s_sleep 4
  s_branch F_poll0
F_poll0_ok:
  s_mov_b64 exec, -1
  s_lshl_b32 s90, s97, 13
  buffer_load_dwordx4 v[88:91], v10, s[12:15], s90 offen offset:0 sc1
  buffer_load_dwordx4 v[92:95], v10, s[12:15], s90 offen offset:2048 sc1
  s_add_u32 s90, s90, 4096
  buffer_load_dwordx4 v[96:99], v10, s[12:15], s90 offen offset:0 sc1
  buffer_load_dwordx4 v[100:103], v10, s[12:15], s90 offen offset:2048 sc1
  s_add_u32 s90, s90, 4096
  s_cmp_eq_u32 s90, 90112
  s_cselect_b32 s90, 0, s90
  buffer_load_dwordx4 v[104:107], v10, s[12:15], s90 offen offset:0 sc1
  buffer_load_dwordx4 v[108:111], v10, s[12:15], s90 offen offset:2048 sc1
  s_add_u32 s90, s90, 4096
  buffer_load_dwordx4 v[112:115], v10, s[12:15], s90 offen offset:0 sc1
  buffer_load_dwordx4 v[116:119], v10, s[12:15], s90 offen offset:2048 sc1
  s_add_u32 s90, s90, 4096
  s_cmp_eq_u32 s90, 90112
  s_cselect_b32 s90, 0, s90
  buffer_load_dwordx4 v[120:123], v10, s[12:15], s90 offen offset:0 sc1
  buffer_load_dwordx4 v[124:127], v10, s[12:15], s90 offen offset:2048 sc1
  s_waitcnt vmcnt(10)
  v_lshlrev_b32 v72, 16, v72
  v_lshlrev_b32 v16, 16, v64
  v_and_b32 v17, 0xffff0000, v64
  v_lshlrev_b32 v18, 16, v65
  v_and_b32 v19, 0xffff0000, v65
  v_lshlrev_b32 v20, 16, v66
  v_and_b32 v21, 0xffff0000, v66
  v_lshlrev_b32 v22, 16, v67
  v_and_b32 v23, 0xffff0000, v67
  v_lshlrev_b32 v24, 16, v68
  v_and_b32 v25, 0xffff0000, v68
  v_lshlrev_b32 v26, 16, v69
  v_and_b32 v27, 0xffff0000, v69
  v_lshlrev_b32 v28, 16, v70
  v_and_b32 v29, 0xffff0000, v70
  v_lshlrev_b32 v30, 16, v71
  v_and_b32 v31, 0xffff0000, v71
  v_add_f32 v16, v16, v72
  v_add_f32 v17, v17, v72
  v_add_f32 v18, v18, v72
  v_add_f32 v19, v19, v72
  v_add_f32 v20, v20, v72
  v_add_f32 v21, v21, v72
  v_add_f32 v22, v22, v72
  v_add_f32 v23, v23, v72
  v_add_f32 v24, v24, v72
  v_add_f32 v25, v25, v72
  v_add_f32 v26, v26, v72
  v_add_f32 v27, v27, v72
  v_add_f32 v28, v28, v72
  v_add_f32 v29, v29, v72
  v_add_f32 v30, v30, v72
  v_add_f32 v31, v31, v72
  s_barrier
  ds_read_b64_tr_b16 v[64:65], v4 offset:0
  ds_read_b64_tr_b16 v[66:67], v4 offset:1024
  ds_read_b64_tr_b16 v[68:69], v7 offset:0
  ds_read_b64_tr_b16 v[70:71], v7 offset:1024
  ds_read_b64_tr_b16 v[72:73], v4 offset:4096
  ds_read_b64_tr_b16 v[74:75], v4 offset:5120
  ds_read_b64_tr_b16 v[76:77], v7 offset:4096
  ds_read_b64_tr_b16 v[78:79], v7 offset:5120
  s_waitcnt lgkmcnt(4)
  s_waitcnt vmcnt(9)
  v_mfma_f32_32x32x16_bf16 v[16:31], v[88:91], v[64:67], v[16:31]
  ds_read_b64_tr_b16 v[80:81], v4 offset:8192
  ds_read_b64_tr_b16 v[82:83], v4 offset:9216
  ds_read_b64_tr_b16 v[84:85], v7 offset:8192
  ds_read_b64_tr_b16 v[86:87], v7 offset:9216
  v_mfma_f32_32x32x16_bf16 v[32:47], v[88:91], v[68:71], 0
  s_add_u32 s90, s90, 4096
  buffer_load_dwordx4 v[128:131], v10, s[12:15], s90 offen offset:0 sc1
  s_waitcnt lgkmcnt(4)
  s_waitcnt vmcnt(9)
  v_mfma_f32_32x32x16_bf16 v[16:31], v[92:95], v[72:75], v[16:31]
  ds_read_b64_tr_b16 v[64:65], v4 offset:12288
  ds_read_b64_tr_b16 v[66:67], v4 offset:13312
  ds_read_b64_tr_b16 v[68:69], v7 offset:12288
  ds_read_b64_tr_b16 v[70:71], v7 offset:13312
  v_mfma_f32_32x32x16_bf16 v[32:47], v[92:95], v[76:79], v[32:47]
  buffer_load_dwordx4 v[132:135], v10, s[12:15], s90 offen offset:2048 sc1
  s_waitcnt lgkmcnt(4)
  s_waitcnt vmcnt(9)
  v_mfma_f32_32x32x16_bf16 v[16:31], v[96:99], v[80:83], v[16:31]
  s_waitcnt lgkmcnt(0)
  s_barrier
  ds_read_b64_tr_b16 v[72:73], v4 offset:16384
  ds_read_b64_tr_b16 v[74:75], v4 offset:17408
  ds_read_b64_tr_b16 v[76:77], v7 offset:16384
  ds_read_b64_tr_b16 v[78:79], v7 offset:17408
  v_mfma_f32_32x32x16_bf16 v[32:47], v[96:99], v[84:87], v[32:47]
  s_add_u32 s90, s90, 4096
  s_cmp_eq_u32 s90, 90112
  s_cselect_b32 s90, 0, s90
  buffer_load_dwordx4 v[136:139], v10, s[12:15], s90 offen offset:0 sc1
  s_waitcnt lgkmcnt(4)
  s_waitcnt vmcnt(9)
  v_mfma_f32_32x32x16_bf16 v[16:31], v[100:103], v[64:67], v[16:31]
  ds_read_b64_tr_b16 v[80:81], v4 offset:20480
  ds_read_b64_tr_b16 v[82:83], v4 offset:21504
  ds_read_b64_tr_b16 v[84:85], v7 offset:20480
  ds_read_b64_tr_b16 v[86:87], v7 offset:21504
  v_mfma_f32_32x32x16_bf16 v[32:47], v[100:103], v[68:71], v[32:47]
  buffer_load_dwordx4 v[140:143], v10, s[12:15], s90 offen offset:2048 sc1
  s_waitcnt lgkmcnt(4)
  s_waitcnt vmcnt(9)
  v_mfma_f32_32x32x16_bf16 v[16:31], v[104:107], v[72:75], v[16:31]
  ds_read_b64_tr_b16 v[64:65], v4 offset:24576
  ds_read_b64_tr_b16 v[66:67], v4 offset:25600
  ds_read_b64_tr_b16 v[68:69], v7 offset:24576
  ds_read_b64_tr_b16 v[70:71], v7 offset:25600
  v_mfma_f32_32x32x16_bf16 v[32:47], v[104:107], v[76:79], v[32:47]
  s_add_u32 s90, s90, 4096
  buffer_load_dwordx4 v[144:147], v10, s[12:15], s90 offen offset:0 sc1
  s_waitcnt lgkmcnt(4)
  s_waitcnt vmcnt(9)
  v_mfma_f32_32x32x16_bf16 v[16:31], v[108:111], v[80:83], v[16:31]
  ds_read_b64_tr_b16 v[72:73], v4 offset:28672
  ds_read_b64_tr_b16 v[74:75], v4 offset:29696
  ds_read_b64_tr_b16 v[76:77], v7 offset:28672
  ds_read_b64_tr_b16 v[78:79], v7 offset:29696
  v_mfma_f32_32x32x16_bf16 v[32:47], v[108:111], v[84:87], v[32:47]
  buffer_load_dwordx4 v[148:151], v10, s[12:15], s90 offen offset:2048 sc1
  s_waitcnt lgkmcnt(4)
  s_waitcnt vmcnt(9)
  v_mfma_f32_32x32x16_bf16 v[16:31], v[112:115], v[64:67], v[16:31]
  s_waitcnt lgkmcnt(0)
  s_barrier
  ds_read_b64_tr_b16 v[80:81], v2 offset:0
  ds_read_b64_tr_b16 v[82:83], v2 offset:1024
  ds_read_b64_tr_b16 v[84:85], v5 offset:0
  ds_read_b64_tr_b16 v[86:87], v5 offset:1024
  v_mfma_f32_32x32x16_bf16 v[32:47], v[112:115], v[68:71], v[32:47]
  s_add_u32 s90, s90, 4096
  s_cmp_eq_u32 s90, 90112
  s_cselect_b32 s90, 0, s90
  buffer_load_dwordx4 v[152:155], v10, s[12:15], s90 offen offset:0 sc1
  s_waitcnt lgkmcnt(4)
  s_waitcnt vmcnt(9)
  v_mfma_f32_32x32x16_bf16 v[16:31], v[116:119], v[72:75], v[16:31]
  ds_read_b64_tr_b16 v[64:65], v2 offset:4096
  ds_read_b64_tr_b16 v[66:67], v2 offset:5120
  ds_read_b64_tr_b16 v[68:69], v5 offset:4096
  ds_read_b64_tr_b16 v[70:71], v5 offset:5120
  v_mfma_f32_32x32x16_bf16 v[32:47], v[116:119], v[76:79], v[32:47]
  buffer_load_dwordx4 v[156:159], v10, s[12:15], s90 offen offset:2048 sc1
  s_waitcnt lgkmcnt(4)
  s_waitcnt vmcnt(9)
  v_mfma_f32_32x32x16_bf16 v[16:31], v[120:123], v[80:83], v[16:31]
  ds_read_b64_tr_b16 v[72:73], v2 offset:8192
  ds_read_b64_tr_b16 v[74:75], v2 offset:9216
  ds_read_b64_tr_b16 v[76:77], v5 offset:8192
  ds_read_b64_tr_b16 v[78:79], v5 offset:9216
  v_mfma_f32_32x32x16_bf16 v[32:47], v[120:123], v[84:87], v[32:47]
  s_add_u32 s90, s90, 4096
  buffer_load_dwordx4 v[160:163], v10, s[12:15], s90 offen offset:0 sc1
  s_waitcnt lgkmcnt(4)
  s_waitcnt vmcnt(9)
  v_mfma_f32_32x32x16_bf16 v[16:31], v[124:127], v[64:67], v[16:31]
  ds_read_b64_tr_b16 v[80:81], v2 offset:12288
  ds_read_b64_tr_b16 v[82:83], v2 offset:13312
  ds_read_b64_tr_b16 v[84:85], v5 offset:12288
  ds_read_b64_tr_b16 v[86:87], v5 offset:13312
  v_mfma_f32_32x32x16_bf16 v[32:47], v[124:127], v[68:71], v[32:47]
  buffer_load_dwordx4 v[164:167], v10, s[12:15], s90 offen offset:2048 sc1
  s_waitcnt lgkmcnt(4)
  s_waitcnt vmcnt(9)
  v_mfma_f32_32x32x16_bf16 v[16:31], v[128:131], v[72:75], v[16:31]
  s_waitcnt lgkmcnt(0)
  s_barrier
  ds_read_b64_tr_b16 v[64:65], v2 offset:16384
  ds_read_b64_tr_b16 v[66:67], v2 offset:17408
  ds_read_b64_tr_b16 v[68:69], v5 offset:16384
  ds_read_b64_tr_b16 v[70:71], v5 offset:17408
  v_mfma_f32_32x32x16_bf16 v[32:47], v[128:131], v[76:79], v[32:47]
  s_add_u32 s90, s90, 4096
  s_cmp_eq_u32 s90, 90112
  s_cselect_b32 s90, 0, s90
  buffer_load_dwordx4 v[168:171], v10, s[12:15], s90 offen offset:0 sc1
  s_waitcnt lgkmcnt(4)
  s_waitcnt vmcnt(9)
  v_mfma_f32_32x32x16_bf16 v[16:31], v[132:135], v[80:83], v[16:31]
  ds_read_b64_tr_b16 v[72:73], v2 offset:20480
  ds_read_b64_tr_b16 v[74:75], v2 offset:21504
  ds_read_b64_tr_b16 v[76:77], v5 offset:20480
  ds_read_b64_tr_b16 v[78:79], v5 offset:21504
  v_mfma_f32_32x32x16_bf16 v[32:47], v[132:135], v[84:87], v[32:47]
  buffer_load_dwordx4 v[172:175], v10, s[12:15], s90 offen offset:2048 sc1
  s_waitcnt lgkmcnt(4)
  s_waitcnt vmcnt(9)
  v_mfma_f32_32x32x16_bf16 v[16:31], v[136:139], v[64:67], v[16:31]
  ds_read_b64_tr_b16 v[80:81], v2 offset:24576
  ds_read_b64_tr_b16 v[82:83], v2 offset:25600
  ds_read_b64_tr_b16 v[84:85], v5 offset:24576
  ds_read_b64_tr_b16 v[86:87], v5 offset:25600
  v_mfma_f32_32x32x16_bf16 v[32:47], v[136:139], v[68:71], v[32:47]
  s_add_u32 s90, s90, 4096
  buffer_load_dwordx4 v[176:179], v10, s[12:15], s90 offen offset:0 sc1
  s_waitcnt lgkmcnt(4)
  s_waitcnt vmcnt(9)
  v_mfma_f32_32x32x16_bf16 v[16:31], v[140:143], v[72:75], v[16:31]
  ds_read_b64_tr_b16 v[64:65], v2 offset:28672
  ds_read_b64_tr_b16 v[66:67], v2 offset:29696
  ds_read_b64_tr_b16 v[68:69], v5 offset:28672
  ds_read_b64_tr_b16 v[70:71], v5 offset:29696
  v_mfma_f32_32x32x16_bf16 v[32:47], v[140:143], v[76:79], v[32:47]
  buffer_load_dwordx4 v[180:183], v10, s[12:15], s90 offen offset:2048 sc1
  s_waitcnt lgkmcnt(4)
  s_waitcnt vmcnt(9)
  v_mfma_f32_32x32x16_bf16 v[16:31], v[144:147], v[80:83], v[16:31]
  s_waitcnt lgkmcnt(0)
  s_barrier
  ds_read_b64_tr_b16 v[72:73], v2 offset:32768
  ds_read_b64_tr_b16 v[74:75], v2 offset:33792
  ds_read_b64_tr_b16 v[76:77], v5 offset:32768
  ds_read_b64_tr_b16 v[78:79], v5 offset:33792
  v_mfma_f32_32x32x16_bf16 v[32:47], v[144:147], v[84:87], v[32:47]
  s_add_u32 s90, s90, 4096
  s_cmp_eq_u32 s90, 90112
  s_cselect_b32 s90, 0, s90
  buffer_load_dwordx4 v[184:187], v10, s[12:15], s90 offen offset:0 sc1
  s_waitcnt lgkmcnt(4)
  s_waitcnt vmcnt(9)
  v_mfma_f32_32x32x16_bf16 v[16:31], v[148:151], v[64:67], v[16:31]
  ds_read_b64_tr_b16 v[80:81], v2 offset:36864
  ds_read_b64_tr_b16 v[82:83], v2 offset:37888
  ds_read_b64_tr_b16 v[84:85], v5 offset:36864
  ds_read_b64_tr_b16 v[86:87], v5 offset:37888
  v_mfma_f32_32x32x16_bf16 v[32:47], v[148:151], v[68:71], v[32:47]
  buffer_load_dwordx4 v[188:191], v10, s[12:15], s90 offen offset:2048 sc1
  s_waitcnt lgkmcnt(4)
  s_waitcnt vmcnt(9)
  v_mfma_f32_32x32x16_bf16 v[16:31], v[152:155], v[72:75], v[16:31]
  ds_read_b64_tr_b16 v[64:65], v2 offset:40960
  ds_read_b64_tr_b16 v[66:67], v2 offset:41984
  ds_read_b64_tr_b16 v[68:69], v5 offset:40960
  ds_read_b64_tr_b16 v[70:71], v5 offset:41984
  v_mfma_f32_32x32x16_bf16 v[32:47], v[152:155], v[76:79], v[32:47]
  s_add_u32 s90, s90, 4096
  buffer_load_dwordx4 v[192:195], v10, s[12:15], s90 offen offset:0 sc1
  s_waitcnt lgkmcnt(4)
  s_waitcnt vmcnt(9)
  v_mfma_f32_32x32x16_bf16 v[16:31], v[156:159], v[80:83], v[16:31]
  ds_read_b64_tr_b16 v[72:73], v2 offset:45056
  ds_read_b64_tr_b16 v[74:75], v2 offset:46080
  ds_read_b64_tr_b16 v[76:77], v5 offset:45056
  ds_read_b64_tr_b16 v[78:79], v5 offset:46080
  v_mfma_f32_32x32x16_bf16 v[32:47], v[156:159], v[84:87], v[32:47]
  buffer_load_dwordx4 v[196:199], v10, s[12:15], s90 offen offset:2048 sc1
  s_waitcnt lgkmcnt(4)
  s_waitcnt vmcnt(9)
  v_mfma_f32_32x32x16_bf16 v[16:31], v[160:163], v[64:67], v[16:31]
  s_waitcnt lgkmcnt(0)
  s_barrier
  ds_read_b64_tr_b16 v[80:81], v2 offset:49152
  ds_read_b64_tr_b16 v[82:83], v2 offset:50176
  ds_read_b64_tr_b16 v[84:85], v5 offset:49152
  ds_read_b64_tr_b16 v[86:87], v5 offset:50176
  v_mfma_f32_32x32x16_bf16 v[32:47], v[160:163], v[68:71], v[32:47]
  s_add_u32 s90, s90, 4096
  s_cmp_eq_u32 s90, 90112
  s_cselect_b32 s90, 0, s90
  buffer_load_dwordx4 v[200:203], v10, s[12:15], s90 offen offset:0 sc1
  s_waitcnt lgkmcnt(4)
  s_waitcnt vmcnt(9)
  v_mfma_f32_32x32x16_bf16 v[16:31], v[164:167], v[72:75], v[16:31]
  ds_read_b64_tr_b16 v[64:65], v2 offset:53248
  ds_read_b64_tr_b16 v[66:67], v2 offset:54272
  ds_read_b64_tr_b16 v[68:69], v5 offset:53248
  ds_read_b64_tr_b16 v[70:71], v5 offset:54272
  v_mfma_f32_32x32x16_bf16 v[32:47], v[164:167], v[76:79], v[32:47]
  buffer_load_dwordx4 v[204:207], v10, s[12:15], s90 offen offset:2048 sc1
  s_waitcnt lgkmcnt(4)
  s_waitcnt vmcnt(9)
  v_mfma_f32_32x32x16_bf16 v[16:31], v[168:171], v[80:83], v[16:31]
  ds_read_b64_tr_b16 v[72:73], v2 offset:57344
  ds_read_b64_tr_b16 v[74:75], v2 offset:58368
  ds_read_b64_tr_b16 v[76:77], v5 offset:57344
  ds_read_b64_tr_b16 v[78:79], v5 offset:58368
  v_mfma_f32_32x32x16_bf16 v[32:47], v[168:171], v[84:87], v[32:47]
  s_add_u32 s90, s90, 4096
  buffer_load_dwordx4 v[208:211], v10, s[12:15], s90 offen offset:0 sc1
  s_waitcnt lgkmcnt(4)
  s_waitcnt vmcnt(9)
  v_mfma_f32_32x32x16_bf16 v[16:31], v[172:175], v[64:67], v[16:31]
  ds_read_b64_tr_b16 v[80:81], v2 offset:61440
  ds_read_b64_tr_b16 v[82:83], v2 offset:62464
  ds_read_b64_tr_b16 v[84:85], v5 offset:61440
  ds_read_b64_tr_b16 v[86:87], v5 offset:62464
  v_mfma_f32_32x32x16_bf16 v[32:47], v[172:175], v[68:71], v[32:47]
  buffer_load_dwordx4 v[212:215], v10, s[12:15], s90 offen offset:2048 sc1
  s_waitcnt lgkmcnt(4)
  s_waitcnt vmcnt(9)
  v_mfma_f32_32x32x16_bf16 v[16:31], v[176:179], v[72:75], v[16:31]
  s_waitcnt lgkmcnt(0)
  s_barrier
  ds_read_b64_tr_b16 v[64:65], v3 offset:0
  ds_read_b64_tr_b16 v[66:67], v3 offset:1024
  ds_read_b64_tr_b16 v[68:69], v6 offset:0
  ds_read_b64_tr_b16 v[70:71], v6 offset:1024
  v_mfma_f32_32x32x16_bf16 v[32:47], v[176:179], v[76:79], v[32:47]
  s_add_u32 s90, s90, 4096
  s_cmp_eq_u32 s90, 90112
  s_cselect_b32 s90, 0, s90
  buffer_load_dwordx4 v[88:91], v10, s[12:15], s90 offen offset:0 sc1
  s_waitcnt lgkmcnt(4)
  s_waitcnt vmcnt(9)
  v_mfma_f32_32x32x16_bf16 v[16:31], v[180:183], v[80:83], v[16:31]
  ds_read_b64_tr_b16 v[72:73], v3 offset:4096
  ds_read_b64_tr_b16 v[74:75], v3 offset:5120
  ds_read_b64_tr_b16 v[76:77], v6 offset:4096
  ds_read_b64_tr_b16 v[78:79], v6 offset:5120
  v_mfma_f32_32x32x16_bf16 v[32:47], v[180:183], v[84:87], v[32:47]
  buffer_load_dwordx4 v[92:95], v10, s[12:15], s90 offen offset:2048 sc1
  s_waitcnt lgkmcnt(4)
  s_waitcnt vmcnt(9)
  v_mfma_f32_32x32x16_bf16 v[16:31], v[184:187], v[64:67], v[16:31]
  ds_read_b64_tr_b16 v[80:81], v3 offset:8192
  ds_read_b64_tr_b16 v[82:83], v3 offset:9216
  ds_read_b64_tr_b16 v[84:85], v6 offset:8192
  ds_read_b64_tr_b16 v[86:87], v6 offset:9216
  v_mfma_f32_32x32x16_bf16 v[32:47], v[184:187], v[68:71], v[32:47]
  s_add_u32 s90, s90, 4096
  buffer_load_dwordx4 v[96:99], v10, s[12:15], s90 offen offset:0 sc1
  s_waitcnt lgkmcnt(4)
  s_waitcnt vmcnt(9)
  v_mfma_f32_32x32x16_bf16 v[16:31], v[188:191], v[72:75], v[16:31]
  ds_read_b64_tr_b16 v[64:65], v3 offset:12288
  ds_read_b64_tr_b16 v[66:67], v3 offset:13312
  ds_read_b64_tr_b16 v[68:69], v6 offset:12288
  ds_read_b64_tr_b16 v[70:71], v6 offset:13312
  v_mfma_f32_32x32x16_bf16 v[32:47], v[188:191], v[76:79], v[32:47]
  buffer_load_dwordx4 v[100:103], v10, s[12:15], s90 offen offset:2048 sc1
  s_waitcnt lgkmcnt(4)
  s_waitcnt vmcnt(9)
  v_mfma_f32_32x32x16_bf16 v[16:31], v[192:195], v[80:83], v[16:31]
  s_waitcnt lgkmcnt(0)
  s_barrier
  ds_read_b64_tr_b16 v[72:73], v3 offset:16384
  ds_read_b64_tr_b16 v[74:75], v3 offset:17408
  ds_read_b64_tr_b16 v[76:77], v6 offset:16384
  ds_read_b64_tr_b16 v[78:79], v6 offset:17408
  v_mfma_f32_32x32x16_bf16 v[32:47], v[192:195], v[84:87], v[32:47]
  s_add_u32 s90, s90, 4096
  s_cmp_eq_u32 s90, 90112
  s_cselect_b32 s90, 0, s90
  buffer_load_dwordx4 v[104:107], v10, s[12:15], s90 offen offset:0 sc1
  s_waitcnt lgkmcnt(4)
  s_waitcnt vmcnt(9)
  v_mfma_f32_32x32x16_bf16 v[16:31], v[196:199], v[64:67], v[16:31]
  ds_read_b64_tr_b16 v[80:81], v3 offset:20480
  ds_read_b64_tr_b16 v[82:83], v3 offset:21504
  ds_read_b64_tr_b16 v[84:85], v6 offset:20480
  ds_read_b64_tr_b16 v[86:87], v6 offset:21504
  v_mfma_f32_32x32x16_bf16 v[32:47], v[196:199], v[68:71], v[32:47]
  buffer_load_dwordx4 v[108:111], v10, s[12:15], s90 offen offset:2048 sc1
  s_waitcnt lgkmcnt(4)
  s_waitcnt vmcnt(9)
  v_mfma_f32_32x32x16_bf16 v[16:31], v[200:203], v[72:75], v[16:31]
  ds_read_b64_tr_b16 v[64:65], v3 offset:24576
  ds_read_b64_tr_b16 v[66:67], v3 offset:25600
  ds_read_b64_tr_b16 v[68:69], v6 offset:24576
  ds_read_b64_tr_b16 v[70:71], v6 offset:25600
  v_mfma_f32_32x32x16_bf16 v[32:47], v[200:203], v[76:79], v[32:47]
  s_mov_b32 exec_lo, 0xffff
  s_mov_b32 exec_hi, 0x0
  buffer_load_dword v14, v13, s[12:15], 0 offen sc1
  s_mov_b64 exec, -1
  s_add_u32 s90, s90, 4096
  buffer_load_dwordx4 v[112:115], v10, s[12:15], s90 offen offset:0 sc1
  s_waitcnt lgkmcnt(4)
  s_waitcnt vmcnt(10)
  v_mfma_f32_32x32x16_bf16 v[16:31], v[204:207], v[80:83], v[16:31]
  ds_read_b64_tr_b16 v[72:73], v3 offset:28672
  ds_read_b64_tr_b16 v[74:75], v3 offset:29696
  ds_read_b64_tr_b16 v[76:77], v6 offset:28672
  ds_read_b64_tr_b16 v[78:79], v6 offset:29696
  v_mfma_f32_32x32x16_bf16 v[32:47], v[204:207], v[84:87], v[32:47]
  buffer_load_dwordx4 v[116:119], v10, s[12:15], s90 offen offset:2048 sc1
  s_waitcnt lgkmcnt(4)
  s_waitcnt vmcnt(10)
  v_mfma_f32_32x32x16_bf16 v[16:31], v[208:211], v[64:67], v[16:31]
  s_waitcnt lgkmcnt(0)
  s_barrier
  ds_read_b64_tr_b16 v[80:81], v3 offset:32768
  ds_read_b64_tr_b16 v[82:83], v3 offset:33792
  ds_read_b64_tr_b16 v[84:85], v6 offset:32768
  ds_read_b64_tr_b16 v[86:87], v6 offset:33792
  v_mfma_f32_32x32x16_bf16 v[32:47], v[208:211], v[68:71], v[32:47]
  s_add_u32 s90, s90, 4096
  s_cmp_eq_u32 s90, 90112
  s_cselect_b32 s90, 0, s90
  buffer_load_dwordx4 v[120:123], v10, s[12:15], s90 offen offset:0 sc1
  s_waitcnt lgkmcnt(4)
  s_waitcnt vmcnt(10)
  v_mfma_f32_32x32x16_bf16 v[16:31], v[212:215], v[72:75], v[16:31]
  ds_read_b64_tr_b16 v[64:65], v3 offset:36864
  ds_read_b64_tr_b16 v[66:67], v3 offset:37888
  ds_read_b64_tr_b16 v[68:69], v6 offset:36864
  ds_read_b64_tr_b16 v[70:71], v6 offset:37888
  v_mfma_f32_32x32x16_bf16 v[32:47], v[212:215], v[76:79], v[32:47]
  buffer_load_dwordx4 v[124:127], v10, s[12:15], s90 offen offset:2048 sc1
  s_waitcnt lgkmcnt(4)
  s_waitcnt vmcnt(10)
  v_mfma_f32_32x32x16_bf16 v[16:31], v[88:91], v[80:83], v[16:31]
  ds_read_b64_tr_b16 v[72:73], v3 offset:40960
  ds_read_b64_tr_b16 v[74:75], v3 offset:41984
  ds_read_b64_tr_b16 v[76:77], v6 offset:40960
  ds_read_b64_tr_b16 v[78:79], v6 offset:41984
  v_mfma_f32_32x32x16_bf16 v[32:47], v[88:91], v[84:87], v[32:47]
  s_add_u32 s90, s90, 4096
  buffer_load_dwordx4 v[128:131], v10, s[12:15], s90 offen offset:0 sc1
  s_waitcnt lgkmcnt(4)
  s_waitcnt vmcnt(10)
  v_mfma_f32_32x32x16_bf16 v[16:31], v[92:95], v[64:67], v[16:31]
  ds_read_b64_tr_b16 v[80:81], v3 offset:45056
  ds_read_b64_tr_b16 v[82:83], v3 offset:46080
  ds_read_b64_tr_b16 v[84:85], v6 offset:45056
  ds_read_b64_tr_b16 v[86:87], v6 offset:46080
  v_mfma_f32_32x32x16_bf16 v[32:47], v[92:95], v[68:71], v[32:47]
  buffer_load_dwordx4 v[132:135], v10, s[12:15], s90 offen offset:2048 sc1
  s_waitcnt lgkmcnt(4)
  s_waitcnt vmcnt(10)
  v_mfma_f32_32x32x16_bf16 v[16:31], v[96:99], v[72:75], v[16:31]
  s_waitcnt lgkmcnt(0)
  s_barrier
  ds_read_b64_tr_b16 v[64:65], v3 offset:49152
  ds_read_b64_tr_b16 v[66:67], v3 offset:50176
  ds_read_b64_tr_b16 v[68:69], v6 offset:49152
  ds_read_b64_tr_b16 v[70:71], v6 offset:50176
  v_mfma_f32_32x32x16_bf16 v[32:47], v[96:99], v[76:79], v[32:47]
  s_waitcnt vmcnt(6)
  s_mov_b32 exec_lo, 0xffff
  s_mov_b32 exec_hi, 0x0
  v_cmp_ne_u32 vcc, s31, v14
  s_nop 3
  s_cbranch_vccz F_poll1_ok
  s_mov_b32 s93, 0
F_poll1:
  buffer_load_dword v14, v13, s[12:15], 0 offen sc1
  s_add_u32 s93, s93, 1
  s_waitcnt vmcnt(0)
  v_cmp_ne_u32 vcc, s31, v14
  s_cmp_ge_u32 s93, 100000
  s_cbranch_scc1 F_poll1_ok
  s_nop 1
  s_cbranch_vccz F_poll1_ok
  s_sleep 4
  s_branch F_poll1
F_poll1_ok:
  s_mov_b64 exec, -1
  s_lshl_b32 s90, s99, 13
  buffer_load_dwordx4 v[136:139], v11, s[12:15], s90 offen offset:0 sc1
  s_waitcnt lgkmcnt(4)
  v_mfma_f32_32x32x16_bf16 v[16:31], v[100:103], v[80:83], v[16:31]
  ds_read_b64_tr_b16 v[72:73], v3 offset:53248
  ds_read_b64_tr_b16 v[74:75], v3 offset:54272
  ds_read_b64_tr_b16 v[76:77], v6 offset:53248
  ds_read_b64_tr_b16 v[78:79], v6 offset:54272
  v_mfma_f32_32x32x16_bf16 v[32:47], v[100:103], v[84:87], v[32:47]
  buffer_load_dwordx4 v[140:143], v11, s[12:15], s90 offen offset:2048 sc1
  s_waitcnt lgkmcnt(4)
  v_mfma_f32_32x32x16_bf16 v[16:31], v[104:107], v[64:67], v[16:31]
  ds_read_b64_tr_b16 v[80:81], v3 offset:57344
  ds_read_b64_tr_b16 v[82:83], v3 offset:58368
  ds_read_b64_tr_b16 v[84:85], v6 offset:57344
  ds_read_b64_tr_b16 v[86:87], v6 offset:58368
  v_mfma_f32_32x32x16_bf16 v[32:47], v[104:107], v[68:71], v[32:47]
  s_add_u32 s90, s90, 4096
  buffer_load_dwordx4 v[144:147], v11, s[12:15], s90 offen offset:0 sc1
  s_waitcnt lgkmcnt(4)
  v_mfma_f32_32x32x16_bf16 v[16:31], v[108:111], v[72:75], v[16:31]
  ds_read_b64_tr_b16 v[64:65], v3 offset:61440
  ds_read_b64_tr_b16 v[66:67], v3 offset:62464
  ds_read_b64_tr_b16 v[68:69], v6 offset:61440
  ds_read_b64_tr_b16 v[70:71], v6 offset:62464
  v_mfma_f32_32x32x16_bf16 v[32:47], v[108:111], v[76:79], v[32:47]
  buffer_load_dwordx4 v[148:151], v11, s[12:15], s90 offen offset:2048 sc1
  s_waitcnt lgkmcnt(4)
  s_waitcnt vmcnt(9)
  v_mfma_f32_32x32x16_bf16 v[16:31], v[112:115], v[80:83], v[16:31]
  s_waitcnt lgkmcnt(0)
  s_barrier
  ds_read_b64_tr_b16 v[72:73], v4 offset:0
  ds_read_b64_tr_b16 v[74:75], v4 offset:1024
  ds_read_b64_tr_b16 v[76:77], v7 offset:0
  ds_read_b64_tr_b16 v[78:79], v7 offset:1024
  v_mfma_f32_32x32x16_bf16 v[32:47], v[112:115], v[84:87], v[32:47]
  s_add_u32 s90, s90, 4096
  s_cmp_eq_u32 s90, 32768
  s_cselect_b32 s90, 0, s90
  buffer_load_dwordx4 v[152:155], v11, s[12:15], s90 offen offset:0 sc1
  s_waitcnt lgkmcnt(4)
  s_waitcnt vmcnt(9)
  v_mfma_f32_32x32x16_bf16 v[16:31], v[116:119], v[64:67], v[16:31]
  ds_read_b64_tr_b16 v[80:81], v4 offset:4096
  ds_read_b64_tr_b16 v[82:83], v4 offset:5120
  ds_read_b64_tr_b16 v[84:85], v7 offset:4096
  ds_read_b64_tr_b16 v[86:87], v7 offset:5120
  v_mfma_f32_32x32x16_bf16 v[32:47], v[116:119], v[68:71], v[32:47]
  buffer_load_dwordx4 v[156:159], v11, s[12:15], s90 offen offset:2048 sc1
  s_waitcnt lgkmcnt(4)
  s_waitcnt vmcnt(9)
  v_mfma_f32_32x32x16_bf16 v[16:31], v[120:123], v[72:75], v[16:31]
  ds_read_b64_tr_b16 v[64:65], v4 offset:8192
  ds_read_b64_tr_b16 v[66:67], v4 offset:9216
  ds_read_b64_tr_b16 v[68:69], v7 offset:8192
  ds_read_b64_tr_b16 v[70:71], v7 offset:9216
  v_mfma_f32_32x32x16_bf16 v[32:47], v[120:123], v[76:79], v[32:47]
  s_add_u32 s90, s90, 4096
  buffer_load_dwordx4 v[160:163], v11, s[12:15], s90 offen offset:0 sc1
  s_waitcnt lgkmcnt(4)
  s_waitcnt vmcnt(9)
  v_mfma_f32_32x32x16_bf16 v[16:31], v[124:127], v[80:83], v[16:31]
  ds_read_b64_tr_b16 v[72:73], v4 offset:12288
  ds_read_b64_tr_b16 v[74:75], v4 offset:13312
  ds_read_b64_tr_b16 v[76:77], v7 offset:12288
  ds_read_b64_tr_b16 v[78:79], v7 offset:13312
  v_mfma_f32_32x32x16_bf16 v[32:47], v[124:127], v[84:87], v[32:47]
  buffer_load_dwordx4 v[164:167], v11, s[12:15], s90 offen offset:2048 sc1
  s_waitcnt lgkmcnt(4)
  s_waitcnt vmcnt(9)
  v_mfma_f32_32x32x16_bf16 v[16:31], v[128:131], v[64:67], v[16:31]
  s_waitcnt lgkmcnt(0)
  s_barrier
  s_mul_i32 s28, s91, 2112
  v_xor_b32 v2, s28, v8
  v_xor_b32 v5, 64, v2
  v_add_u32 v3, 0x10000, v2
  v_add_u32 v4, 0x20000, v2
  v_add_u32 v6, 0x10000, v5
  v_add_u32 v7, 0x20000, v5
  ds_read_b64_tr_b16 v[80:81], v4 offset:16384
  ds_read_b64_tr_b16 v[82:83], v4 offset:17408
  ds_read_b64_tr_b16 v[84:85], v7 offset:16384
  ds_read_b64_tr_b16 v[86:87], v7 offset:17408
  v_mfma_f32_32x32x16_bf16 v[32:47], v[128:131], v[68:71], v[32:47]
  s_add_u32 s90, s90, 4096
  s_cmp_eq_u32 s90, 32768
  s_cselect_b32 s90, 0, s90
  buffer_load_dwordx4 v[168:171], v11, s[12:15], s90 offen offset:0 sc1
  s_waitcnt lgkmcnt(4)
  s_waitcnt vmcnt(9)
  v_mfma_f32_32x32x16_bf16 v[16:31], v[132:135], v[72:75], v[16:31]
  ds_read_b64_tr_b16 v[64:65], v4 offset:20480
  ds_read_b64_tr_b16 v[66:67], v4 offset:21504
  ds_read_b64_tr_b16 v[68:69], v7 offset:20480
  ds_read_b64_tr_b16 v[70:71], v7 offset:21504
  v_mfma_f32_32x32x16_bf16 v[32:47], v[132:135], v[76:79], v[32:47]
  buffer_load_dwordx4 v[172:175], v11, s[12:15], s90 offen offset:2048 sc1
  s_waitcnt lgkmcnt(4)
  s_waitcnt vmcnt(9)
  v_mfma_f32_32x32x16_bf16 v[16:31], v[80:83], v[136:139], v[16:31]
  ds_read_b64_tr_b16 v[72:73], v4 offset:24576
  ds_read_b64_tr_b16 v[74:75], v4 offset:25600
  ds_read_b64_tr_b16 v[76:77], v7 offset:24576
  ds_read_b64_tr_b16 v[78:79], v7 offset:25600
  v_mfma_f32_32x32x16_bf16 v[48:63], v[84:87], v[136:139], 0
  s_add_u32 s90, s90, 4096
  buffer_load_dwordx4 v[176:179], v11, s[12:15], s90 offen offset:0 sc1
  s_waitcnt lgkmcnt(4)
  s_waitcnt vmcnt(9)
  v_mfma_f32_32x32x16_bf16 v[16:31], v[64:67], v[140:143], v[16:31]
  ds_read_b64_tr_b16 v[80:81], v4 offset:28672
  ds_read_b64_tr_b16 v[82:83], v4 offset:29696
  ds_read_b64_tr_b16 v[84:85], v7 offset:28672
  ds_read_b64_tr_b16 v[86:87], v7 offset:29696
  v_mfma_f32_32x32x16_bf16 v[48:63], v[68:71], v[140:143], v[48:63]
  buffer_load_dwordx4 v[180:183], v11, s[12:15], s90 offen offset:2048 sc1
  s_waitcnt lgkmcnt(4)
  s_waitcnt vmcnt(9)
  v_mfma_f32_32x32x16_bf16 v[16:31], v[72:75], v[144:147], v[16:31]
  s_waitcnt lgkmcnt(0)
  s_barrier
  ds_read_b64_tr_b16 v[64:65], v2 offset:0
  ds_read_b64_tr_b16 v[66:67], v2 offset:1024
  ds_read_b64_tr_b16 v[68:69], v5 offset:0
  ds_read_b64_tr_b16 v[70:71], v5 offset:1024
  v_mfma_f32_32x32x16_bf16 v[48:63], v[76:79], v[144:147], v[48:63]
  s_add_u32 s90, s90, 4096
  s_cmp_eq_u32 s90, 32768
  s_cselect_b32 s90, 0, s90
  buffer_load_dwordx4 v[184:187], v11, s[12:15], s90 offen offset:0 sc1
  s_waitcnt lgkmcnt(4)
  s_waitcnt vmcnt(9)
  v_mfma_f32_32x32x16_bf16 v[16:31], v[80:83], v[148:151], v[16:31]
  ds_read_b64_tr_b16 v[72:73], v2 offset:4096
  ds_read_b64_tr_b16 v[74:75], v2 offset:5120
  ds_read_b64_tr_b16 v[76:77], v5 offset:4096
  ds_read_b64_tr_b16 v[78:79], v5 offset:5120
  v_mfma_f32_32x32x16_bf16 v[48:63], v[84:87], v[148:151], v[48:63]
  buffer_load_dwordx4 v[188:191], v11, s[12:15], s90 offen offset:2048 sc1
  s_waitcnt lgkmcnt(4)
  s_waitcnt vmcnt(9)
  v_mfma_f32_32x32x16_bf16 v[16:31], v[64:67], v[152:155], v[16:31]
  ds_read_b64_tr_b16 v[80:81], v2 offset:8192
  ds_read_b64_tr_b16 v[82:83], v2 offset:9216
  ds_read_b64_tr_b16 v[84:85], v5 offset:8192
  ds_read_b64_tr_b16 v[86:87], v5 offset:9216
  v_mfma_f32_32x32x16_bf16 v[48:63], v[68:71], v[152:155], v[48:63]
  s_add_u32 s90, s90, 4096
  buffer_load_dwordx4 v[192:195], v11, s[12:15], s90 offen offset:0 sc1
  s_waitcnt lgkmcnt(4)
  s_waitcnt vmcnt(9)
  v_mfma_f32_32x32x16_bf16 v[16:31], v[72:75], v[156:159], v[16:31]
  ds_read_b64_tr_b16 v[64:65], v2 offset:12288
  ds_read_b64_tr_b16 v[66:67], v2 offset:13312
  ds_read_b64_tr_b16 v[68:69], v5 offset:12288
  ds_read_b64_tr_b16 v[70:71], v5 offset:13312
  v_mfma_f32_32x32x16_bf16 v[48:63], v[76:79], v[156:159], v[48:63]
  buffer_load_dwordx4 v[196:199], v11, s[12:15], s90 offen offset:2048 sc1
  s_waitcnt lgkmcnt(4)
  s_waitcnt vmcnt(9)
  v_mfma_f32_32x32x16_bf16 v[16:31], v[80:83], v[160:163], v[16:31]
  ds_write_b128 v246, v[32:35] offset:0
  ds_write_b128 v246, v[36:39] offset:1024
  ds_write_b128 v246, v[40:43] offset:2048
  ds_write_b128 v246, v[44:47] offset:3072
  s_waitcnt lgkmcnt(0)
  s_barrier
  ds_read_b128 v[224:227], v9 offset:0
  ds_read_b128 v[228:231], v9 offset:1024
  ds_read_b128 v[232:235], v9 offset:2048
  ds_read_b128 v[236:239], v9 offset:3072
  ds_read_b64_tr_b16 v[72:73], v2 offset:16384
  ds_read_b64_tr_b16 v[74:75], v2 offset:17408
  ds_read_b64_tr_b16 v[76:77], v5 offset:16384
  ds_read_b64_tr_b16 v[78:79], v5 offset:17408
  v_mfma_f32_32x32x16_bf16 v[48:63], v[84:87], v[160:163], v[48:63]
  s_waitcnt lgkmcnt(4)
  s_waitcnt vmcnt(8)
  v_mfma_f32_32x32x16_bf16 v[16:31], v[64:67], v[164:167], v[16:31]
  ds_read_b64_tr_b16 v[80:81], v2 offset:20480
  ds_read_b64_tr_b16 v[82:83], v2 offset:21504
  ds_read_b64_tr_b16 v[84:85], v5 offset:20480
  ds_read_b64_tr_b16 v[86:87], v5 offset:21504
  v_mfma_f32_32x32x16_bf16 v[48:63], v[68:71], v[164:167], v[48:63]
  s_waitcnt lgkmcnt(4)
  s_waitcnt vmcnt(7)
  v_mfma_f32_32x32x16_bf16 v[16:31], v[72:75], v[168:171], v[16:31]
  ds_read_b64_tr_b16 v[64:65], v2 offset:24576
  ds_read_b64_tr_b16 v[66:67], v2 offset:25600
  ds_read_b64_tr_b16 v[68:69], v5 offset:24576
  ds_read_b64_tr_b16 v[70:71], v5 offset:25600
  v_mfma_f32_32x32x16_bf16 v[48:63], v[76:79], v[168:171], v[48:63]
  s_waitcnt lgkmcnt(4)
  s_waitcnt vmcnt(6)
  v_mfma_f32_32x32x16_bf16 v[16:31], v[80:83], v[172:175], v[16:31]
  ds_read_b64_tr_b16 v[72:73], v2 offset:28672
  ds_read_b64_tr_b16 v[74:75], v2 offset:29696
  ds_read_b64_tr_b16 v[76:77], v5 offset:28672
  ds_read_b64_tr_b16 v[78:79], v5 offset:29696
  v_mfma_f32_32x32x16_bf16 v[48:63], v[84:87], v[172:175], v[48:63]
  s_waitcnt lgkmcnt(4)
  s_waitcnt vmcnt(5)
  v_mfma_f32_32x32x16_bf16 v[16:31], v[64:67], v[176:179], v[16:31]
  s_waitcnt lgkmcnt(0)
  s_barrier
  ds_read_b64_tr_b16 v[80:81], v2 offset:32768
  ds_read_b64_tr_b16 v[82:83], v2 offset:33792
  ds_read_b64_tr_b16 v[84:85], v5 offset:32768
  ds_read_b64_tr_b16 v[86:87], v5 offset:33792
  v_mfma_f32_32x32x16_bf16 v[48:63], v[68:71], v[176:179], v[48:63]
  s_waitcnt lgkmcnt(4)
  s_waitcnt vmcnt(4)
  v_mfma_f32_32x32x16_bf16 v[16:31], v[72:75], v[180:183], v[16:31]
  ds_read_b64_tr_b16 v[64:65], v2 offset:36864
  ds_read_b64_tr_b16 v[66:67], v2 offset:37888
  ds_read_b64_tr_b16 v[68:69], v5 offset:36864
  ds_read_b64_tr_b16 v[70:71], v5 offset:37888
  v_mfma_f32_32x32x16_bf16 v[48:63], v[76:79], v[180:183], v[48:63]
  s_waitcnt lgkmcnt(4)
  s_waitcnt vmcnt(3)
  v_mfma_f32_32x32x16_bf16 v[16:31], v[80:83], v[184:187], v[16:31]
  ds_read_b64_tr_b16 v[72:73], v2 offset:40960
  ds_read_b64_tr_b16 v[74:75], v2 offset:41984
  ds_read_b64_tr_b16 v[76:77], v5 offset:40960
  ds_read_b64_tr_b16 v[78:79], v5 offset:41984
  v_mfma_f32_32x32x16_bf16 v[48:63], v[84:87], v[184:187], v[48:63]
  s_waitcnt lgkmcnt(4)
  s_waitcnt vmcnt(2)
  v_mfma_f32_32x32x16_bf16 v[16:31], v[64:67], v[188:191], v[16:31]
  ds_read_b64_tr_b16 v[80:81], v2 offset:45056
  ds_read_b64_tr_b16 v[82:83], v2 offset:46080
  ds_read_b64_tr_b16 v[84:85], v5 offset:45056
  ds_read_b64_tr_b16 v[86:87], v5 offset:46080
  v_mfma_f32_32x32x16_bf16 v[48:63], v[68:71], v[188:191], v[48:63]
  s_waitcnt lgkmcnt(4)
  s_waitcnt vmcnt(1)
  v_mfma_f32_32x32x16_bf16 v[16:31], v[72:75], v[192:195], v[16:31]
  v_mfma_f32_32x32x16_bf16 v[48:63], v[76:79], v[192:195], v[48:63]
  s_waitcnt lgkmcnt(0)
  s_waitcnt vmcnt(0)
  v_mfma_f32_32x32x16_bf16 v[16:31], v[80:83], v[196:199], v[16:31]
  v_mfma_f32_32x32x16_bf16 v[48:63], v[84:87], v[196:199], v[48:63]
  s_mov_b32 s4, s80
  s_mov_b32 s5, s81
  s_mov_b32 s6, 2097152
  s_mov_b32 s7, 0x00020000
  s_nop 7
  ds_write_b128 v247, v[48:51] offset:16384
  ds_write_b128 v247, v[52:55] offset:17408
  ds_write_b128 v247, v[56:59] offset:18432
  ds_write_b128 v247, v[60:63] offset:19456
  v_pk_add_f32 v[16:17], v[16:17], v[224:225]
  v_pk_add_f32 v[18:19], v[18:19], v[226:227]
  v_pk_add_f32 v[20:21], v[20:21], v[228:229]
  v_pk_add_f32 v[22:23], v[22:23], v[230:231]
  v_pk_add_f32 v[24:25], v[24:25], v[232:233]
  v_pk_add_f32 v[26:27], v[26:27], v[234:235]
  v_pk_add_f32 v[28:29], v[28:29], v[236:237]
  v_pk_add_f32 v[30:31], v[30:31], v[238:239]
  s_waitcnt lgkmcnt(0)
  s_barrier
  ds_read_b128 v[224:227], v9 offset:16384
  ds_read_b128 v[228:231], v9 offset:17408
  ds_read_b128 v[232:235], v9 offset:18432
  ds_read_b128 v[236:239], v9 offset:19456
  s_waitcnt lgkmcnt(0)
  v_pk_add_f32 v[16:17], v[16:17], v[224:225]
  v_pk_add_f32 v[18:19], v[18:19], v[226:227]
  v_pk_add_f32 v[20:21], v[20:21], v[228:229]
  v_pk_add_f32 v[22:23], v[22:23], v[230:231]
  v_pk_add_f32 v[24:25], v[24:25], v[232:233]
  v_pk_add_f32 v[26:27], v[26:27], v[234:235]
  v_pk_add_f32 v[28:29], v[28:29], v[236:237]
  v_pk_add_f32 v[30:31], v[30:31], v[238:239]
  v_cvt_pk_bf16_f32 v32, v16, v17
  v_cvt_pk_bf16_f32 v33, v18, v19
  v_cvt_pk_bf16_f32 v34, v20, v21
  v_cvt_pk_bf16_f32 v35, v22, v23
  v_cvt_pk_bf16_f32 v36, v24, v25
  v_cvt_pk_bf16_f32 v37, v26, v27
  v_cvt_pk_bf16_f32 v38, v28, v29
  v_cvt_pk_bf16_f32 v39, v30, v31
  v_permlane32_swap_b32 v32, v34
  v_permlane32_swap_b32 v33, v35
  v_permlane32_swap_b32 v36, v38
  v_permlane32_swap_b32 v37, v39
  buffer_store_dwordx4 v[32:35], v15, s[4:7], 0 offen nt
  buffer_store_dwordx4 v[36:39], v15, s[4:7], 0 offen offset:32 nt
  s_endpgm
F_load:
  s_lshl_b32 s28, s2, 3
  s_add_u32 s28, s28, s3
  s_cmp_lg_u32 s28, 4
  s_cbranch_scc1 F_l_go
  v_lshlrev_b32 v2, 7, v1
  v_add_u32 v2, 10522624, v2
  v_add_u32 v3, 8192, v2
  v_lshrrev_b32 v4, 4, v1
  v_lshlrev_b32 v4, 13, v4
  v_and_b32 v5, 15, v1
  v_lshl_add_u32 v4, v5, 8, v4
  v_add_u32 v4, 10588160, v4
  v_add_u32 v5, 32768, v4
  s_mov_b32 s93, 0
F_ep0:
  buffer_load_dword v6, v2, s[12:15], 0 offen sc1
  s_add_u32 s93, s93, 1
  s_waitcnt vmcnt(0)
  v_cmp_ne_u32 vcc, s31, v6
  s_cmp_ge_u32 s93, 100000
  s_cbranch_scc1 F_ep0_ok
  s_nop 1
  s_cbranch_vccz F_ep0_ok
  s_sleep 2
  s_branch F_ep0
F_ep0_ok:
  s_mov_b64 exec, -1
  s_mov_b32 s93, 0
F_ep1:
  buffer_load_dword v6, v3, s[12:15], 0 offen sc1
  s_add_u32 s93, s93, 1
  s_waitcnt vmcnt(0)
  v_cmp_ne_u32 vcc, s31, v6
  s_cmp_ge_u32 s93, 100000
  s_cbranch_scc1 F_ep1_ok
  s_nop 1
  s_cbranch_vccz F_ep1_ok
  s_sleep 2
  s_branch F_ep1
F_ep1_ok:
  s_mov_b64 exec, -1
  s_mov_b32 s93, 0
F_ep2:
  buffer_load_dword v6, v4, s[12:15], 0 offen sc1
  s_add_u32 s93, s93, 1
  s_waitcnt vmcnt(0)
  v_cmp_ne_u32 vcc, s31, v6
  s_cmp_ge_u32 s93, 100000
  s_cbranch_scc1 F_ep2_ok
  s_nop 1
  s_cbranch_vccz F_ep2_ok
  s_sleep 2
  s_branch F_ep2
F_ep2_ok:
  s_mov_b64 exec, -1
  s_mov_b32 s93, 0
F_ep3:
  buffer_load_dword v6, v5, s[12:15], 0 offen sc1
  s_add_u32 s93, s93, 1
  s_waitcnt vmcnt(0)
  v_cmp_ne_u32 vcc, s31, v6
  s_cmp_ge_u32 s93, 100000
  s_cbranch_scc1 F_ep3_ok
  s_nop 1
  s_cbranch_vccz F_ep3_ok
  s_sleep 2
  s_branch F_ep3
F_ep3_ok:
  s_mov_b64 exec, -1
  v_mov_b32 v2, 10485760
  v_mov_b32 v3, s31
  s_mov_b64 exec, 1
  buffer_store_dword v3, v2, s[12:15], 0 offen
  s_mov_b64 exec, -1
F_l_go:
  s_setprio 0
  s_bitcmp0_b32 s2, 3
  s_cbranch_scc1 F_l_A
  s_lshl_b32 s28, s24, 12
  s_add_u32 m0, s28, 32768
  s_add_u32 s96, s96, 524288
  s_cmp_eq_u32 s96, 5767168
  s_cselect_b32 s96, 0, s96
  buffer_load_dwordx4 v240, s[16:19], s96 offen offset:0 lds
  buffer_load_dwordx4 v241, s[16:19], s96 offen offset:1024 lds
  buffer_load_dwordx4 v242, s[16:19], s96 offen offset:2048 lds
  buffer_load_dwordx4 v243, s[16:19], s96 offen offset:3072 lds
  s_lshl_b32 s28, s24, 12
  s_add_u32 m0, s28, 49152
  s_add_u32 s96, s96, 524288
  s_cmp_eq_u32 s96, 5767168
  s_cselect_b32 s96, 0, s96
  buffer_load_dwordx4 v240, s[16:19], s96 offen offset:0 lds
  buffer_load_dwordx4 v241, s[16:19], s96 offen offset:1024 lds
  buffer_load_dwordx4 v242, s[16:19], s96 offen offset:2048 lds
  buffer_load_dwordx4 v243, s[16:19], s96 offen offset:3072 lds
  s_lshl_b32 s28, s24, 12
  s_add_u32 m0, s28, 65536
  s_add_u32 s96, s96, 524288
  s_cmp_eq_u32 s96, 5767168
  s_cselect_b32 s96, 0, s96
  buffer_load_dwordx4 v240, s[16:19], s96 offen offset:0 lds
  buffer_load_dwordx4 v241, s[16:19], s96 offen offset:1024 lds
  buffer_load_dwordx4 v242, s[16:19], s96 offen offset:2048 lds
  buffer_load_dwordx4 v243, s[16:19], s96 offen offset:3072 lds
  s_waitcnt vmcnt(24)
  s_barrier
  s_lshl_b32 s28, s24, 12
  s_add_u32 m0, s28, 81920
  s_add_u32 s96, s96, 524288
  s_cmp_eq_u32 s96, 5767168
  s_cselect_b32 s96, 0, s96
  buffer_load_dwordx4 v240, s[16:19], s96 offen offset:0 lds
  buffer_load_dwordx4 v241, s[16:19], s96 offen offset:1024 lds
  buffer_load_dwordx4 v242, s[16:19], s96 offen offset:2048 lds
  s_waitcnt vmcnt(23)
  s_barrier
  buffer_load_dwordx4 v243, s[16:19], s96 offen offset:3072 lds
  s_lshl_b32 s28, s24, 12
  s_add_u32 m0, s28, 98304
  s_add_u32 s96, s96, 524288
  s_cmp_eq_u32 s96, 5767168
  s_cselect_b32 s96, 0, s96
  buffer_load_dwordx4 v240, s[16:19], s96 offen offset:0 lds
  buffer_load_dwordx4 v241, s[16:19], s96 offen offset:1024 lds
  s_waitcnt vmcnt(22)
  s_barrier
  buffer_load_dwordx4 v242, s[16:19], s96 offen offset:2048 lds
  buffer_load_dwordx4 v243, s[16:19], s96 offen offset:3072 lds
  s_waitcnt vmcnt(20)
  s_barrier
  s_lshl_b32 s28, s24, 12
  s_add_u32 m0, s28, 114688
  s_add_u32 s96, s96, 524288
  s_cmp_eq_u32 s96, 5767168
  s_cselect_b32 s96, 0, s96
  buffer_load_dwordx4 v240, s[16:19], s96 offen offset:0 lds
  buffer_load_dwordx4 v241, s[16:19], s96 offen offset:1024 lds
  buffer_load_dwordx4 v242, s[16:19], s96 offen offset:2048 lds
  s_waitcnt vmcnt(19)
  s_barrier
  buffer_load_dwordx4 v243, s[16:19], s96 offen offset:3072 lds
  s_lshl_b32 s28, s24, 12
  s_add_u32 m0, s28, 131072
  s_add_u32 s96, s96, 524288
  s_cmp_eq_u32 s96, 5767168
  s_cselect_b32 s96, 0, s96
  buffer_load_dwordx4 v240, s[16:19], s96 offen offset:0 lds
  buffer_load_dwordx4 v241, s[16:19], s96 offen offset:1024 lds
  s_waitcnt vmcnt(18)
  s_barrier
  buffer_load_dwordx4 v242, s[16:19], s96 offen offset:2048 lds
  buffer_load_dwordx4 v243, s[16:19], s96 offen offset:3072 lds
  s_waitcnt vmcnt(16)
  s_barrier
  s_lshl_b32 s28, s24, 12
  s_add_u32 m0, s28, 147456
  s_mul_i32 s96, s99, 131072
  buffer_load_dwordx4 v244, s[20:23], s96 offen offset:0 lds
  buffer_load_dwordx4 v245, s[20:23], s96 offen offset:1024 lds
  buffer_load_dwordx4 v246, s[20:23], s96 offen offset:2048 lds
  s_waitcnt vmcnt(15)
  s_barrier
  buffer_load_dwordx4 v247, s[20:23], s96 offen offset:3072 lds
  s_lshl_b32 s28, s24, 12
  s_add_u32 m0, s28, 0
  s_add_u32 s96, s96, 131072
  s_cmp_eq_u32 s96, 524288
  s_cselect_b32 s96, 0, s96
  buffer_load_dwordx4 v244, s[20:23], s96 offen offset:0 lds
  buffer_load_dwordx4 v245, s[20:23], s96 offen offset:1024 lds
  s_waitcnt vmcnt(14)
  s_barrier
  buffer_load_dwordx4 v246, s[20:23], s96 offen offset:2048 lds
  buffer_load_dwordx4 v247, s[20:23], s96 offen offset:3072 lds
  s_waitcnt vmcnt(12)
  s_barrier
  s_lshl_b32 s28, s24, 12
  s_add_u32 m0, s28, 16384
  s_add_u32 s96, s96, 131072
  s_cmp_eq_u32 s96, 524288
  s_cselect_b32 s96, 0, s96
  buffer_load_dwordx4 v244, s[20:23], s96 offen offset:0 lds
  buffer_load_dwordx4 v245, s[20:23], s96 offen offset:1024 lds
  buffer_load_dwordx4 v246, s[20:23], s96 offen offset:2048 lds
  s_waitcnt vmcnt(11)
  s_barrier
  buffer_load_dwordx4 v247, s[20:23], s96 offen offset:3072 lds
  s_lshl_b32 s28, s24, 12
  s_add_u32 m0, s28, 32768
  s_add_u32 s96, s96, 131072
  s_cmp_eq_u32 s96, 524288
  s_cselect_b32 s96, 0, s96
  buffer_load_dwordx4 v244, s[20:23], s96 offen offset:0 lds
  buffer_load_dwordx4 v245, s[20:23], s96 offen offset:1024 lds
  s_waitcnt vmcnt(10)
  s_barrier
  buffer_load_dwordx4 v246, s[20:23], s96 offen offset:2048 lds
  buffer_load_dwordx4 v247, s[20:23], s96 offen offset:3072 lds
  s_waitcnt vmcnt(8)
  s_barrier
  s_waitcnt vmcnt(4)
  s_barrier
  s_waitcnt vmcnt(0)
  s_barrier
  s_branch F_l_end
F_l_A:
  s_lshl_b32 s28, s24, 12
  s_add_u32 m0, s28, 0
  s_add_u32 s96, s96, 524288
  s_cmp_eq_u32 s96, 5767168
  s_cselect_b32 s96, 0, s96
  buffer_load_dwordx4 v240, s[16:19], s96 offen offset:0 lds
  buffer_load_dwordx4 v241, s[16:19], s96 offen offset:1024 lds
  buffer_load_dwordx4 v242, s[16:19], s96 offen offset:2048 lds
  buffer_load_dwordx4 v243, s[16:19], s96 offen offset:3072 lds
  s_lshl_b32 s28, s24, 12
  s_add_u32 m0, s28, 16384
  s_add_u32 s96, s96, 524288
  s_cmp_eq_u32 s96, 5767168
  s_cselect_b32 s96, 0, s96
  buffer_load_dwordx4 v240, s[16:19], s96 offen offset:0 lds
  buffer_load_dwordx4 v241, s[16:19], s96 offen offset:1024 lds
  buffer_load_dwordx4 v242, s[16:19], s96 offen offset:2048 lds
  buffer_load_dwordx4 v243, s[16:19], s96 offen offset:3072 lds
  s_lshl_b32 s28, s24, 12
  s_add_u32 m0, s28, 32768
  s_add_u32 s96, s96, 524288
  s_cmp_eq_u32 s96, 5767168
  s_cselect_b32 s96, 0, s96
  buffer_load_dwordx4 v240, s[16:19], s96 offen offset:0 lds
  buffer_load_dwordx4 v241, s[16:19], s96 offen offset:1024 lds
  buffer_load_dwordx4 v242, s[16:19], s96 offen offset:2048 lds
  buffer_load_dwordx4 v243, s[16:19], s96 offen offset:3072 lds
  s_waitcnt vmcnt(16)
  s_barrier
  s_lshl_b32 s28, s24, 12
  s_add_u32 m0, s28, 49152
  s_add_u32 s96, s96, 524288
  s_cmp_eq_u32 s96, 5767168
  s_cselect_b32 s96, 0, s96
  buffer_load_dwordx4 v240, s[16:19], s96 offen offset:0 lds
  buffer_load_dwordx4 v241, s[16:19], s96 offen offset:1024 lds
  buffer_load_dwordx4 v242, s[16:19], s96 offen offset:2048 lds
  buffer_load_dwordx4 v243, s[16:19], s96 offen offset:3072 lds
  s_waitcnt vmcnt(16)
  s_barrier
  s_lshl_b32 s28, s24, 12
  s_add_u32 m0, s28, 65536
  s_add_u32 s96, s96, 524288
  s_cmp_eq_u32 s96, 5767168
  s_cselect_b32 s96, 0, s96
  buffer_load_dwordx4 v240, s[16:19], s96 offen offset:0 lds
  buffer_load_dwordx4 v241, s[16:19], s96 offen offset:1024 lds
  buffer_load_dwordx4 v242, s[16:19], s96 offen offset:2048 lds
  s_waitcnt vmcnt(15)
  s_barrier
  buffer_load_dwordx4 v243, s[16:19], s96 offen offset:3072 lds
  s_lshl_b32 s28, s24, 12
  s_add_u32 m0, s28, 81920
  s_add_u32 s96, s96, 524288
  s_cmp_eq_u32 s96, 5767168
  s_cselect_b32 s96, 0, s96
  buffer_load_dwordx4 v240, s[16:19], s96 offen offset:0 lds
  buffer_load_dwordx4 v241, s[16:19], s96 offen offset:1024 lds
  s_waitcnt vmcnt(14)
  s_barrier
  buffer_load_dwordx4 v242, s[16:19], s96 offen offset:2048 lds
  buffer_load_dwordx4 v243, s[16:19], s96 offen offset:3072 lds
  s_lshl_b32 s28, s24, 12
  s_add_u32 m0, s28, 98304
  s_add_u32 s96, s96, 524288
  s_cmp_eq_u32 s96, 5767168
  s_cselect_b32 s96, 0, s96
  buffer_load_dwordx4 v240, s[16:19], s96 offen offset:0 lds
  buffer_load_dwordx4 v241, s[16:19], s96 offen offset:1024 lds
  s_waitcnt vmcnt(14)
  s_barrier
  buffer_load_dwordx4 v242, s[16:19], s96 offen offset:2048 lds
  buffer_load_dwordx4 v243, s[16:19], s96 offen offset:3072 lds
  s_lshl_b32 s28, s24, 12
  s_add_u32 m0, s28, 114688
  s_add_u32 s96, s96, 524288
  s_cmp_eq_u32 s96, 5767168
  s_cselect_b32 s96, 0, s96
  buffer_load_dwordx4 v240, s[16:19], s96 offen offset:0 lds
  s_waitcnt vmcnt(13)
  s_barrier
  buffer_load_dwordx4 v241, s[16:19], s96 offen offset:1024 lds
  buffer_load_dwordx4 v242, s[16:19], s96 offen offset:2048 lds
  buffer_load_dwordx4 v243, s[16:19], s96 offen offset:3072 lds
  s_waitcnt vmcnt(12)
  s_barrier
  s_lshl_b32 s28, s24, 12
  s_add_u32 m0, s28, 131072
  s_add_u32 s96, s96, 524288
  s_cmp_eq_u32 s96, 5767168
  s_cselect_b32 s96, 0, s96
  buffer_load_dwordx4 v240, s[16:19], s96 offen offset:0 lds
  buffer_load_dwordx4 v241, s[16:19], s96 offen offset:1024 lds
  buffer_load_dwordx4 v242, s[16:19], s96 offen offset:2048 lds
  buffer_load_dwordx4 v243, s[16:19], s96 offen offset:3072 lds
  s_waitcnt vmcnt(12)
  s_barrier
  s_lshl_b32 s28, s24, 12
  s_add_u32 m0, s28, 147456
  s_mul_i32 s96, s99, 131072
  buffer_load_dwordx4 v244, s[20:23], s96 offen offset:0 lds
  buffer_load_dwordx4 v245, s[20:23], s96 offen offset:1024 lds
  buffer_load_dwordx4 v246, s[20:23], s96 offen offset:2048 lds
  s_waitcnt vmcnt(11)
  s_barrier
  buffer_load_dwordx4 v247, s[20:23], s96 offen offset:3072 lds
  s_lshl_b32 s28, s24, 12
  s_add_u32 m0, s28, 0
  s_add_u32 s96, s96, 131072
  s_cmp_eq_u32 s96, 524288
  s_cselect_b32 s96, 0, s96
  buffer_load_dwordx4 v244, s[20:23], s96 offen offset:0 lds
  buffer_load_dwordx4 v245, s[20:23], s96 offen offset:1024 lds
  s_waitcnt vmcnt(10)
  s_barrier
  buffer_load_dwordx4 v246, s[20:23], s96 offen offset:2048 lds
  buffer_load_dwordx4 v247, s[20:23], s96 offen offset:3072 lds
  s_lshl_b32 s28, s24, 12
  s_add_u32 m0, s28, 16384
  s_add_u32 s96, s96, 131072
  s_cmp_eq_u32 s96, 524288
  s_cselect_b32 s96, 0, s96
  buffer_load_dwordx4 v244, s[20:23], s96 offen offset:0 lds
  buffer_load_dwordx4 v245, s[20:23], s96 offen offset:1024 lds
  s_waitcnt vmcnt(10)
  s_barrier
  buffer_load_dwordx4 v246, s[20:23], s96 offen offset:2048 lds
  buffer_load_dwordx4 v247, s[20:23], s96 offen offset:3072 lds
  s_lshl_b32 s28, s24, 12
  s_add_u32 m0, s28, 32768
  s_add_u32 s96, s96, 131072
  s_cmp_eq_u32 s96, 524288
  s_cselect_b32 s96, 0, s96
  buffer_load_dwordx4 v244, s[20:23], s96 offen offset:0 lds
  s_waitcnt vmcnt(9)
  s_barrier
  buffer_load_dwordx4 v245, s[20:23], s96 offen offset:1024 lds
  buffer_load_dwordx4 v246, s[20:23], s96 offen offset:2048 lds
  buffer_load_dwordx4 v247, s[20:23], s96 offen offset:3072 lds
  s_waitcnt vmcnt(8)
  s_barrier
  s_waitcnt vmcnt(4)
  s_barrier
  s_waitcnt vmcnt(0)
  s_barrier
F_l_end:
L_end:
  s_endpgm
CODE_END:
.section .rodata,"a"
.p2align 6
.amdhsa_kernel parallel_sum__sliding_block__mixer_token_mlp__prompt_kernel
  .amdhsa_next_free_vgpr 256
  .amdhsa_next_free_sgpr 102
  .amdhsa_accum_offset 256
  .amdhsa_group_segment_fixed_size 0
  .amdhsa_kernarg_size 88
  .amdhsa_user_sgpr_count 2
  .amdhsa_user_sgpr_kernarg_segment_ptr 1
  .amdhsa_system_sgpr_workgroup_id_x 1
.end_amdhsa_kernel
```
